```python
import torch

def _softmax(x, axis=-1):
    return torch.softmax(x, dim=axis)

def _gelu(x):
    return torch.nn.functional.gelu(x, approximate='tanh')

def _silu(x):
    return torch.nn.functional.silu(x)

def _sigmoid(x):
    return torch.sigmoid(x)

def _layernorm(x, axis=-1, eps=1e-05):
    m = x.mean(dim=axis, keepdim=True)
    v = x.var(dim=axis, keepdim=True, unbiased=False)
    return (x - m) / torch.sqrt(v + eps)

def _scatter_add(tgt, idx, src, axis=0):
    return tgt.clone().index_add_(axis, idx, src)

def _segment_sum(src, seg, n):
    out = torch.zeros((n,) + src.shape[1:], dtype=src.dtype)
    return out.index_add_(0, seg, src)

def _pad(x, pw):
    flat = tuple((v for pair in reversed(pw) for v in pair))
    return torch.nn.functional.pad(x, flat)
kernel_name = 'gated_mix__memory_aug_recurrent_mem_tr__dense_activation_relu__prompt'

def setup_inputs():

    _w = lambda a: (lambda t: t.to(torch.bfloat16) if t.is_floating_point() else t)(torch.as_tensor(a))

    def _A_setup():
        B, S, Dm = (1, 2048, 512)
        H, Dh = (32, 128)
        M, seg = (8, 32)
        seg = min(seg, S)
        S = S // seg * seg
        return {'x': _w((lambda *s: torch.randn(*s, dtype=torch.bfloat16) * 0.05)(B, S, Dm)), 'mem0': _w((lambda *s: torch.randn(*s, dtype=torch.bfloat16) * 1.6)(B, M, Dm)), 'Wq': _w((lambda *s: torch.randn(*s, dtype=torch.bfloat16) * 0.8)(Dm, H, Dh) * Dm ** (-0.5)), 'Wk': _w((lambda *s: torch.randn(*s, dtype=torch.bfloat16) * 0.8)(Dm, H, Dh) * Dm ** (-0.5)), 'Wv': _w((lambda *s: torch.randn(*s, dtype=torch.bfloat16) * 1.6)(Dm, H, Dh) * Dm ** (-0.5)), 'Wo': _w((lambda *s: torch.randn(*s, dtype=torch.bfloat16) * 1.6)(H, Dh, Dm) * (H * Dh) ** (-0.5)), 'seg_len': seg}
    _A_in = _A_setup()

    def _B_setup():
        B, S, D, Dff = (1, 2048, 512, 1792)
        return {'x': _w((lambda *s: torch.randn(*s, dtype=torch.bfloat16) * 0.05)(B, S, D)), 'w1': _w((lambda *s: torch.randn(*s, dtype=torch.bfloat16) * 0.1)(D, Dff)), 'w2': _w((lambda *s: torch.randn(*s, dtype=torch.bfloat16) * 0.1)(Dff, D))}
    _B_in = _B_setup()
    return {'A_x': _A_in['x'], 'A_mem0': _A_in['mem0'], 'A_Wq': _A_in['Wq'], 'A_Wk': _A_in['Wk'], 'A_Wv': _A_in['Wv'], 'A_Wo': _A_in['Wo'], 'A_seg_len': _A_in['seg_len'], 'B_x': _B_in['x'], 'B_w1': _B_in['w1'], 'B_w2': _B_in['w2'], 'gate_w': _w((lambda *s: torch.randn(*s, dtype=torch.bfloat16) * 0.05)(512) * 16.0)}

def reference(A_x, A_mem0, A_Wq, A_Wk, A_Wv, A_Wo, A_seg_len, B_x, B_w1, B_w2, gate_w):

    def _A_ref(x, mem0, Wq, Wk, Wv, Wo, seg_len):
        B, S, Dm = x.shape
        H, Dh = (Wq.shape[1], Wq.shape[2])
        M = mem0.shape[1]
        scale = Dh ** (-0.5)
        n_seg = S // seg_len
        L = M + seg_len
        idx = torch.arange(L)
        mask = (idx[:, None] < M) | (idx[:, None] >= idx[None, :])
        mem = mem0
        outs = []
        for s in range(n_seg):
            xs = x[:, s * seg_len:(s + 1) * seg_len, :].clone()
            h = torch.concatenate([mem, xs], axis=1)
            q = torch.einsum('btd,dhe->bhte', h, Wq)
            k = torch.einsum('btd,dhe->bhte', h, Wk)
            v = torch.einsum('btd,dhe->bhte', h, Wv)
            scores = torch.einsum('bhqe,bhke->bhqk', q, k) * scale
            scores = torch.where(mask[None, None], scores, -1000000000.0)
            p = _softmax(scores, axis=-1)
            o = torch.einsum('bhqk,bhke->bhqe', p, v)
            o = torch.einsum('bhte,hed->btd', o, Wo)
            mem = o[:, :M, :].clone()
            outs.append(o[:, M:, :])
        return torch.concatenate(outs, axis=1)

    def _B_ref(x, w1, w2):
        h = torch.einsum('bsd,df->bsf', x, w1)
        zero = torch.zeros_like(h)
        h = torch.maximum(h, zero)
        return torch.einsum('bsf,fd->bsd', h, w2)
    x = A_x
    g = _sigmoid((x * gate_w).sum(-1, keepdims=True))
    a = _A_ref(x, A_mem0, A_Wq, A_Wk, A_Wv, A_Wo, A_seg_len)
    b = _B_ref(x, B_w1, B_w2)
    return g * a + (1 - g) * b
```

```asm
; @launch grid=(256,1,1) block=(256,1,1) lds=163840
.amdgcn_target "amdgcn-amd-amdhsa--gfx950"
.text
.globl gated_mix__memory_aug_recurrent_mem_tr__dense_activation_relu__prompt_kernel
.p2align 8
.type gated_mix__memory_aug_recurrent_mem_tr__dense_activation_relu__prompt_kernel,@function
gated_mix__memory_aug_recurrent_mem_tr__dense_activation_relu__prompt_kernel:
  s_cmp_ge_u32 s2, 256
  s_cbranch_scc1 L_end
  s_load_dwordx2 s[8:9], s[0:1], 104
  s_load_dwordx2 s[10:11], s[0:1], 96
  v_lshrrev_b32 v2, 6, v0
  s_nop 1
  v_readfirstlane_b32 s4, v2
  s_waitcnt lgkmcnt(0)
  s_getreg_b32 s6, hwreg(HW_REG_XCC_ID, 0, 4)
  s_and_b32 s6, s6, 7
  s_cmp_eq_u32 s4, 0
  s_cbranch_scc0 L_t_notw0
  s_lshl_b32 s14, s6, 5
  v_mov_b32 v3, s14
  v_mov_b32 v4, 1
  s_mov_b64 exec, 1
  global_atomic_add v5, v3, v4, s[10:11] sc0 sc1
  s_waitcnt vmcnt(0)
  v_mov_b32 v6, 30976
  ds_write_b32 v6, v5
  s_waitcnt lgkmcnt(0)
  s_mov_b64 exec, -1
L_t_notw0:
  s_barrier
  v_mov_b32 v6, 30976
  ds_read_b32 v5, v6
  s_waitcnt lgkmcnt(0)
  v_readfirstlane_b32 s7, v5
  s_barrier
  s_mov_b32 s98, s6
  s_mov_b32 s99, s7
  s_cmp_ge_u32 s7, 32
  s_cbranch_scc1 L_end
  s_cmp_eq_u32 s6, 0
  s_cbranch_scc0 L_worker
  s_mov_b32 s5, s7
  v_and_b32 v1, 63, v0
  v_and_b32 v32, 15, v1
  v_lshrrev_b32 v33, 4, v1
  v_bfe_u32 v34, v1, 4, 1
  v_lshrrev_b32 v35, 5, v1
  v_lshlrev_b32 v36, 4, v0
  s_lshl_b32 s40, s5, 13
  v_add_u32 v37, s40, v36
  v_mov_b32 v40, -1
  v_mov_b32 v41, -1
  v_mov_b32 v42, -1
  v_mov_b32 v43, -1
  v_add_u32 v38, 0x1000, v37
  v_add_u32 v39, 0x40000, v37
  v_add_u32 v44, 0x41000, v37
  global_store_dwordx4 v37, v[40:43], s[8:9]
  global_store_dwordx4 v38, v[40:43], s[8:9]
  global_store_dwordx4 v39, v[40:43], s[8:9]
  global_store_dwordx4 v44, v[40:43], s[8:9]
  s_lshl_b32 s40, s5, 8
  s_add_u32 s40, s40, 524288
  v_lshlrev_b32 v45, 2, v1
  v_add_u32 v45, s40, v45
  v_add_u32 v46, 0x2000, v45
  global_store_dword v45, v40, s[8:9]
  global_store_dword v46, v40, s[8:9]
  s_lshl_b32 s40, s5, 10
  s_add_u32 s40, s40, 589824
  v_lshlrev_b32 v45, 2, v0
  v_add_u32 v45, s40, v45
  v_mov_b32 v46, 0
  global_store_dword v45, v46, s[8:9] sc1
  s_load_dwordx2 s[88:89], s[0:1], 8
  v_and_b32 v64, 7, v0
  v_lshrrev_b32 v65, 3, v0
  v_and_b32 v66, 1, v65
  v_lshrrev_b32 v67, 1, v65
  v_lshrrev_b32 v68, 3, v67
  v_lshlrev_b32 v68, 7, v68
  v_bfe_u32 v69, v67, 2, 1
  v_lshlrev_b32 v69, 6, v69
  v_add_u32 v68, v68, v69
  v_and_b32 v69, 1, v67
  v_lshlrev_b32 v69, 4, v69
  v_add_u32 v68, v68, v69
  v_lshlrev_b32 v69, 3, v66
  v_add_u32 v68, v68, v69
  v_bfe_u32 v69, v67, 1, 1
  v_add_u32 v68, v68, v69
  v_lshlrev_b32 v68, 1, v68
  v_lshlrev_b32 v64, 10, v64
  v_add_u32 v68, v68, v64
  s_waitcnt lgkmcnt(0)
  s_mov_b32 s90, 8192
  s_mov_b32 s91, 0x00020000
  buffer_load_ushort v72, v68, s[88:91], 0 offen offset:0
  buffer_load_ushort v73, v68, s[88:91], 0 offen offset:64
  buffer_load_ushort v74, v68, s[88:91], 0 offen offset:4
  buffer_load_ushort v75, v68, s[88:91], 0 offen offset:68
  buffer_load_ushort v76, v68, s[88:91], 0 offen offset:8
  buffer_load_ushort v77, v68, s[88:91], 0 offen offset:72
  buffer_load_ushort v78, v68, s[88:91], 0 offen offset:12
  buffer_load_ushort v79, v68, s[88:91], 0 offen offset:76
  buffer_load_ushort v80, v68, s[88:91], 0 offen offset:512
  buffer_load_ushort v81, v68, s[88:91], 0 offen offset:576
  buffer_load_ushort v82, v68, s[88:91], 0 offen offset:516
  buffer_load_ushort v83, v68, s[88:91], 0 offen offset:580
  buffer_load_ushort v84, v68, s[88:91], 0 offen offset:520
  buffer_load_ushort v85, v68, s[88:91], 0 offen offset:584
  buffer_load_ushort v86, v68, s[88:91], 0 offen offset:524
  buffer_load_ushort v87, v68, s[88:91], 0 offen offset:588
  s_load_dwordx2 s[12:13], s[0:1], 40
  s_load_dwordx2 s[82:83], s[0:1], 16
  s_load_dwordx2 s[84:85], s[0:1], 24
  s_load_dwordx2 s[86:87], s[0:1], 32
  s_lshl_b32 s40, s5, 17
  s_lshl_b32 s41, s4, 8
  s_add_u32 s40, s40, s41
  v_lshlrev_b32 v37, 2, v32
  v_lshlrev_b32 v38, 12, v33
  v_add3_u32 v37, v37, v38, s40
  v_lshlrev_b32 v4, 4, v1
  s_lshl_b32 s41, s4, 15
  s_add_u32 s41, s41, 32768
  v_add_u32 v4, s41, v4
  s_lshl_b32 s40, s5, 8
  s_lshl_b32 s41, s4, 6
  s_add_u32 s40, s40, s41
  v_lshlrev_b32 v36, 2, v32
  v_lshlrev_b32 v38, 15, v33
  v_add3_u32 v36, v36, v38, s40
  s_waitcnt lgkmcnt(0)
  s_mov_b32 s14, 0x400000
  s_mov_b32 s15, 0x00020000
  s_add_u32 s41, s4, 0
  s_and_b32 s41, s41, 3
  s_lshl_b32 s44, s41, 15
  s_add_u32 s41, s4, 1
  s_and_b32 s41, s41, 3
  s_lshl_b32 s45, s41, 15
  s_add_u32 s41, s4, 2
  s_and_b32 s41, s41, 3
  s_lshl_b32 s46, s41, 15
  s_add_u32 s41, s4, 3
  s_and_b32 s41, s41, 3
  s_lshl_b32 s47, s41, 15
  s_lshl_b32 s43, s4, 11
  v_lshlrev_b32 v64, 4, v1
  v_add_u32 v14, s43, v64
  s_lshl_b32 s40, s5, 13
  s_add_u32 s20, s8, 1048576
  s_addc_u32 s21, s9, 0
  s_add_u32 s20, s20, s40
  s_addc_u32 s21, s21, 0
  s_mov_b32 s42, 0
  s_mov_b32 s50, 0
  s_mov_b32 s51, 262144
  s_mov_b32 s52, 16384
  s_mov_b32 s53, 278528
  s_mov_b32 s54, 131072
  s_mov_b32 s55, 393216
  s_mov_b32 s56, 147456
  s_mov_b32 s57, 409600
  s_mov_b32 s58, 8192
  s_mov_b32 s59, 270336
  s_mov_b32 s60, 24576
  s_mov_b32 s61, 286720
  s_mov_b32 s62, 139264
  s_mov_b32 s63, 401408
  s_mov_b32 s64, 155648
  s_mov_b32 s65, 417792
  s_mov_b32 s66, 524288
  s_mov_b32 s67, 786432
  s_mov_b32 s68, 540672
  s_mov_b32 s69, 802816
  s_mov_b32 s70, 655360
  s_mov_b32 s71, 917504
  s_mov_b32 s72, 671744
  s_mov_b32 s73, 933888
  s_mov_b32 s74, 532480
  s_mov_b32 s75, 794624
  s_mov_b32 s76, 548864
  s_mov_b32 s77, 811008
  s_mov_b32 s78, 663552
  s_mov_b32 s79, 925696
  s_mov_b32 s80, 679936
  s_mov_b32 s81, 942080
  s_mov_b64 s[100:101], s[12:13]
  s_add_u32 s41, s44, 0
  buffer_load_dword v128, v37, s[12:15], s41 offen
  s_add_u32 s41, s44, 1024
  buffer_load_dword v129, v37, s[12:15], s41 offen
  s_add_u32 s41, s44, 2048
  buffer_load_dword v130, v37, s[12:15], s41 offen
  s_add_u32 s41, s44, 3072
  buffer_load_dword v131, v37, s[12:15], s41 offen
  s_add_u32 s41, s44, 16384
  buffer_load_dword v132, v37, s[12:15], s41 offen
  s_add_u32 s41, s44, 17408
  buffer_load_dword v133, v37, s[12:15], s41 offen
  s_add_u32 s41, s44, 18432
  buffer_load_dword v134, v37, s[12:15], s41 offen
  s_add_u32 s41, s44, 19456
  buffer_load_dword v135, v37, s[12:15], s41 offen
  s_add_u32 s41, s44, 64
  buffer_load_dword v136, v37, s[12:15], s41 offen
  s_add_u32 s41, s44, 1088
  buffer_load_dword v137, v37, s[12:15], s41 offen
  s_add_u32 s41, s44, 2112
  buffer_load_dword v138, v37, s[12:15], s41 offen
  s_add_u32 s41, s44, 3136
  buffer_load_dword v139, v37, s[12:15], s41 offen
  s_add_u32 s41, s44, 16448
  buffer_load_dword v140, v37, s[12:15], s41 offen
  s_add_u32 s41, s44, 17472
  buffer_load_dword v141, v37, s[12:15], s41 offen
  s_add_u32 s41, s44, 18496
  buffer_load_dword v142, v37, s[12:15], s41 offen
  s_add_u32 s41, s44, 19520
  buffer_load_dword v143, v37, s[12:15], s41 offen
  s_add_u32 s41, s44, 128
  buffer_load_dword v144, v37, s[12:15], s41 offen
  s_add_u32 s41, s44, 1152
  buffer_load_dword v145, v37, s[12:15], s41 offen
  s_add_u32 s41, s44, 2176
  buffer_load_dword v146, v37, s[12:15], s41 offen
  s_add_u32 s41, s44, 3200
  buffer_load_dword v147, v37, s[12:15], s41 offen
  s_add_u32 s41, s44, 16512
  buffer_load_dword v148, v37, s[12:15], s41 offen
  s_add_u32 s41, s44, 17536
  buffer_load_dword v149, v37, s[12:15], s41 offen
  s_add_u32 s41, s44, 18560
  buffer_load_dword v150, v37, s[12:15], s41 offen
  s_add_u32 s41, s44, 19584
  buffer_load_dword v151, v37, s[12:15], s41 offen
  s_add_u32 s41, s44, 192
  buffer_load_dword v152, v37, s[12:15], s41 offen
  s_add_u32 s41, s44, 1216
  buffer_load_dword v153, v37, s[12:15], s41 offen
  s_add_u32 s41, s44, 2240
  buffer_load_dword v154, v37, s[12:15], s41 offen
  s_add_u32 s41, s44, 3264
  buffer_load_dword v155, v37, s[12:15], s41 offen
  s_add_u32 s41, s44, 16576
  buffer_load_dword v156, v37, s[12:15], s41 offen
  s_add_u32 s41, s44, 17600
  buffer_load_dword v157, v37, s[12:15], s41 offen
  s_add_u32 s41, s44, 18624
  buffer_load_dword v158, v37, s[12:15], s41 offen
  s_add_u32 s41, s44, 19648
  buffer_load_dword v159, v37, s[12:15], s41 offen
  s_add_u32 s41, s45, 0
  buffer_load_dword v160, v37, s[12:15], s41 offen
  s_add_u32 s41, s45, 1024
  buffer_load_dword v161, v37, s[12:15], s41 offen
  s_add_u32 s41, s45, 2048
  buffer_load_dword v162, v37, s[12:15], s41 offen
  s_add_u32 s41, s45, 3072
  buffer_load_dword v163, v37, s[12:15], s41 offen
  s_add_u32 s41, s45, 16384
  buffer_load_dword v164, v37, s[12:15], s41 offen
  s_add_u32 s41, s45, 17408
  buffer_load_dword v165, v37, s[12:15], s41 offen
  s_add_u32 s41, s45, 18432
  buffer_load_dword v166, v37, s[12:15], s41 offen
  s_add_u32 s41, s45, 19456
  buffer_load_dword v167, v37, s[12:15], s41 offen
  s_waitcnt vmcnt(40)
  v_lshl_or_b32 v96, v73, 16, v72
  v_lshl_or_b32 v97, v75, 16, v74
  v_lshl_or_b32 v98, v77, 16, v76
  v_lshl_or_b32 v99, v79, 16, v78
  v_lshl_or_b32 v100, v81, 16, v80
  v_lshl_or_b32 v101, v83, 16, v82
  v_lshl_or_b32 v102, v85, 16, v84
  v_lshl_or_b32 v103, v87, 16, v86
  v_lshlrev_b32 v64, 4, v0
  v_add_u32 v65, 0x1000, v64
  ds_write_b128 v64, v[96:99]
  ds_write_b128 v65, v[100:103]
  s_barrier
  s_cmp_eq_u32 s4, 0
  s_cbranch_scc0 L_c_noready
  v_mov_b32 v38, 4
  v_mov_b32 v39, 1
  s_mov_b64 exec, 1
  global_atomic_add v38, v39, s[10:11] sc1
  s_mov_b64 exec, -1
L_c_noready:
  s_add_u32 s41, s45, 64
  buffer_load_dword v168, v37, s[12:15], s41 offen
  s_add_u32 s41, s45, 1088
  buffer_load_dword v169, v37, s[12:15], s41 offen
  s_add_u32 s41, s45, 2112
  buffer_load_dword v170, v37, s[12:15], s41 offen
  s_add_u32 s41, s45, 3136
  buffer_load_dword v171, v37, s[12:15], s41 offen
  s_add_u32 s41, s45, 16448
  buffer_load_dword v172, v37, s[12:15], s41 offen
  s_add_u32 s41, s45, 17472
  buffer_load_dword v173, v37, s[12:15], s41 offen
  s_add_u32 s41, s45, 18496
  buffer_load_dword v174, v37, s[12:15], s41 offen
  s_add_u32 s41, s45, 19520
  buffer_load_dword v175, v37, s[12:15], s41 offen
  s_add_u32 s41, s46, 0
  buffer_load_dword a64, v37, s[12:15], s41 offen
  s_add_u32 s41, s46, 1024
  buffer_load_dword a65, v37, s[12:15], s41 offen
  s_add_u32 s41, s46, 2048
  buffer_load_dword a66, v37, s[12:15], s41 offen
  s_add_u32 s41, s46, 3072
  buffer_load_dword a67, v37, s[12:15], s41 offen
  s_add_u32 s41, s46, 16384
  buffer_load_dword a68, v37, s[12:15], s41 offen
  s_add_u32 s41, s46, 17408
  buffer_load_dword a69, v37, s[12:15], s41 offen
  s_add_u32 s41, s46, 18432
  buffer_load_dword a70, v37, s[12:15], s41 offen
  s_add_u32 s41, s46, 19456
  buffer_load_dword a71, v37, s[12:15], s41 offen
  s_add_u32 s41, s46, 64
  buffer_load_dword a72, v37, s[12:15], s41 offen
  s_add_u32 s41, s46, 1088
  buffer_load_dword a73, v37, s[12:15], s41 offen
  s_add_u32 s41, s46, 2112
  buffer_load_dword a74, v37, s[12:15], s41 offen
  s_add_u32 s41, s46, 3136
  buffer_load_dword a75, v37, s[12:15], s41 offen
  s_add_u32 s41, s46, 16448
  buffer_load_dword a76, v37, s[12:15], s41 offen
  s_add_u32 s41, s46, 17472
  buffer_load_dword a77, v37, s[12:15], s41 offen
  s_add_u32 s41, s46, 18496
  buffer_load_dword a78, v37, s[12:15], s41 offen
  s_add_u32 s41, s46, 19520
  buffer_load_dword a79, v37, s[12:15], s41 offen
  s_add_u32 s41, s47, 0
  buffer_load_dword a80, v37, s[12:15], s41 offen
  s_add_u32 s41, s47, 1024
  buffer_load_dword a81, v37, s[12:15], s41 offen
  s_add_u32 s41, s47, 2048
  buffer_load_dword a82, v37, s[12:15], s41 offen
  s_add_u32 s41, s47, 3072
  buffer_load_dword a83, v37, s[12:15], s41 offen
  s_add_u32 s41, s47, 16384
  buffer_load_dword a84, v37, s[12:15], s41 offen
  s_add_u32 s41, s47, 17408
  buffer_load_dword a85, v37, s[12:15], s41 offen
  s_add_u32 s41, s47, 18432
  buffer_load_dword a86, v37, s[12:15], s41 offen
  s_add_u32 s41, s47, 19456
  buffer_load_dword a87, v37, s[12:15], s41 offen
  s_add_u32 s41, s47, 64
  buffer_load_dword a88, v37, s[12:15], s41 offen
  s_add_u32 s41, s47, 1088
  buffer_load_dword a89, v37, s[12:15], s41 offen
  s_add_u32 s41, s47, 2112
  buffer_load_dword a90, v37, s[12:15], s41 offen
  s_add_u32 s41, s47, 3136
  buffer_load_dword a91, v37, s[12:15], s41 offen
  s_add_u32 s41, s47, 16448
  buffer_load_dword a92, v37, s[12:15], s41 offen
  s_add_u32 s41, s47, 17472
  buffer_load_dword a93, v37, s[12:15], s41 offen
  s_add_u32 s41, s47, 18496
  buffer_load_dword a94, v37, s[12:15], s41 offen
  s_add_u32 s41, s47, 19520
  buffer_load_dword a95, v37, s[12:15], s41 offen
  s_add_u32 s41, s47, 128
  buffer_load_dword v176, v37, s[12:15], s41 offen
  s_add_u32 s41, s47, 1152
  buffer_load_dword v177, v37, s[12:15], s41 offen
  s_add_u32 s41, s47, 2176
  buffer_load_dword v178, v37, s[12:15], s41 offen
  s_add_u32 s41, s47, 3200
  buffer_load_dword v179, v37, s[12:15], s41 offen
  s_add_u32 s41, s47, 16512
  buffer_load_dword v180, v37, s[12:15], s41 offen
  s_add_u32 s41, s47, 17536
  buffer_load_dword v181, v37, s[12:15], s41 offen
  s_add_u32 s41, s47, 18560
  buffer_load_dword v182, v37, s[12:15], s41 offen
  s_add_u32 s41, s47, 19584
  buffer_load_dword v183, v37, s[12:15], s41 offen
  s_add_u32 s41, s47, 192
  buffer_load_dword v184, v37, s[12:15], s41 offen
  s_add_u32 s41, s47, 1216
  buffer_load_dword v185, v37, s[12:15], s41 offen
  s_add_u32 s41, s47, 2240
  buffer_load_dword v186, v37, s[12:15], s41 offen
  s_add_u32 s41, s47, 3264
  buffer_load_dword v187, v37, s[12:15], s41 offen
  s_add_u32 s41, s47, 16576
  buffer_load_dword v188, v37, s[12:15], s41 offen
  s_add_u32 s41, s47, 17600
  buffer_load_dword v189, v37, s[12:15], s41 offen
  s_add_u32 s41, s47, 18624
  buffer_load_dword v190, v37, s[12:15], s41 offen
  s_add_u32 s41, s47, 19648
  buffer_load_dword v191, v37, s[12:15], s41 offen
  s_cmp_eq_u32 s4, 0
  s_cbranch_scc0 L_c_wl1
  s_mov_b64 s[12:13], s[82:83]
  buffer_load_dword a0, v36, s[12:15], s50 offen
  buffer_load_dword a1, v36, s[12:15], s51 offen
  buffer_load_dword a2, v36, s[12:15], s52 offen
  buffer_load_dword a3, v36, s[12:15], s53 offen
  buffer_load_dword a4, v36, s[12:15], s54 offen
  buffer_load_dword a5, v36, s[12:15], s55 offen
  buffer_load_dword a6, v36, s[12:15], s56 offen
  buffer_load_dword a7, v36, s[12:15], s57 offen
  buffer_load_dword a8, v36, s[12:15], s58 offen
  buffer_load_dword a9, v36, s[12:15], s59 offen
  buffer_load_dword a10, v36, s[12:15], s60 offen
  buffer_load_dword a11, v36, s[12:15], s61 offen
  buffer_load_dword a12, v36, s[12:15], s62 offen
  buffer_load_dword a13, v36, s[12:15], s63 offen
  buffer_load_dword a14, v36, s[12:15], s64 offen
  buffer_load_dword a15, v36, s[12:15], s65 offen
  buffer_load_dword a16, v36, s[12:15], s66 offen
  buffer_load_dword a17, v36, s[12:15], s67 offen
  buffer_load_dword a18, v36, s[12:15], s68 offen
  buffer_load_dword a19, v36, s[12:15], s69 offen
  buffer_load_dword a20, v36, s[12:15], s70 offen
  buffer_load_dword a21, v36, s[12:15], s71 offen
  buffer_load_dword a22, v36, s[12:15], s72 offen
  buffer_load_dword a23, v36, s[12:15], s73 offen
  buffer_load_dword a24, v36, s[12:15], s74 offen
  buffer_load_dword a25, v36, s[12:15], s75 offen
  buffer_load_dword a26, v36, s[12:15], s76 offen
  buffer_load_dword a27, v36, s[12:15], s77 offen
  buffer_load_dword a28, v36, s[12:15], s78 offen
  buffer_load_dword a29, v36, s[12:15], s79 offen
  buffer_load_dword a30, v36, s[12:15], s80 offen
  buffer_load_dword a31, v36, s[12:15], s81 offen
  s_add_u32 s12, s12, 0x100000
  s_addc_u32 s13, s13, 0
  s_sub_u32 s14, s14, 0x100000
  buffer_load_dword a32, v36, s[12:15], s50 offen
  buffer_load_dword a33, v36, s[12:15], s51 offen
  buffer_load_dword a34, v36, s[12:15], s52 offen
  buffer_load_dword a35, v36, s[12:15], s53 offen
  buffer_load_dword a36, v36, s[12:15], s54 offen
  buffer_load_dword a37, v36, s[12:15], s55 offen
  buffer_load_dword a38, v36, s[12:15], s56 offen
  buffer_load_dword a39, v36, s[12:15], s57 offen
  buffer_load_dword a40, v36, s[12:15], s58 offen
  buffer_load_dword a41, v36, s[12:15], s59 offen
  buffer_load_dword a42, v36, s[12:15], s60 offen
  buffer_load_dword a43, v36, s[12:15], s61 offen
  buffer_load_dword a44, v36, s[12:15], s62 offen
  buffer_load_dword a45, v36, s[12:15], s63 offen
  buffer_load_dword a46, v36, s[12:15], s64 offen
  buffer_load_dword a47, v36, s[12:15], s65 offen
  buffer_load_dword a48, v36, s[12:15], s66 offen
  buffer_load_dword a49, v36, s[12:15], s67 offen
  buffer_load_dword a50, v36, s[12:15], s68 offen
  buffer_load_dword a51, v36, s[12:15], s69 offen
  buffer_load_dword a52, v36, s[12:15], s70 offen
  buffer_load_dword a53, v36, s[12:15], s71 offen
  buffer_load_dword a54, v36, s[12:15], s72 offen
  buffer_load_dword a55, v36, s[12:15], s73 offen
  buffer_load_dword a56, v36, s[12:15], s74 offen
  buffer_load_dword a57, v36, s[12:15], s75 offen
  buffer_load_dword a58, v36, s[12:15], s76 offen
  buffer_load_dword a59, v36, s[12:15], s77 offen
  buffer_load_dword a60, v36, s[12:15], s78 offen
  buffer_load_dword a61, v36, s[12:15], s79 offen
  buffer_load_dword a62, v36, s[12:15], s80 offen
  buffer_load_dword a63, v36, s[12:15], s81 offen
  s_add_u32 s12, s12, 0x100000
  s_addc_u32 s13, s13, 0
  s_sub_u32 s14, s14, 0x100000
  buffer_load_dword v192, v36, s[12:15], s50 offen
  buffer_load_dword v193, v36, s[12:15], s51 offen
  buffer_load_dword v194, v36, s[12:15], s52 offen
  buffer_load_dword v195, v36, s[12:15], s53 offen
  buffer_load_dword v196, v36, s[12:15], s54 offen
  buffer_load_dword v197, v36, s[12:15], s55 offen
  buffer_load_dword v198, v36, s[12:15], s56 offen
  buffer_load_dword v199, v36, s[12:15], s57 offen
  buffer_load_dword v200, v36, s[12:15], s58 offen
  buffer_load_dword v201, v36, s[12:15], s59 offen
  buffer_load_dword v202, v36, s[12:15], s60 offen
  buffer_load_dword v203, v36, s[12:15], s61 offen
  buffer_load_dword v204, v36, s[12:15], s62 offen
  buffer_load_dword v205, v36, s[12:15], s63 offen
  buffer_load_dword v206, v36, s[12:15], s64 offen
  buffer_load_dword v207, v36, s[12:15], s65 offen
  buffer_load_dword v208, v36, s[12:15], s66 offen
  buffer_load_dword v209, v36, s[12:15], s67 offen
  buffer_load_dword v210, v36, s[12:15], s68 offen
  buffer_load_dword v211, v36, s[12:15], s69 offen
  buffer_load_dword v212, v36, s[12:15], s70 offen
  buffer_load_dword v213, v36, s[12:15], s71 offen
  buffer_load_dword v214, v36, s[12:15], s72 offen
  buffer_load_dword v215, v36, s[12:15], s73 offen
  buffer_load_dword v216, v36, s[12:15], s74 offen
  buffer_load_dword v217, v36, s[12:15], s75 offen
  buffer_load_dword v218, v36, s[12:15], s76 offen
  buffer_load_dword v219, v36, s[12:15], s77 offen
  buffer_load_dword v220, v36, s[12:15], s78 offen
  buffer_load_dword v221, v36, s[12:15], s79 offen
  buffer_load_dword v222, v36, s[12:15], s80 offen
  buffer_load_dword v223, v36, s[12:15], s81 offen
  s_add_u32 s12, s12, 0x100000
  s_addc_u32 s13, s13, 0
  s_sub_u32 s14, s14, 0x100000
  buffer_load_dword v224, v36, s[12:15], s50 offen
  buffer_load_dword v225, v36, s[12:15], s51 offen
  buffer_load_dword v226, v36, s[12:15], s52 offen
  buffer_load_dword v227, v36, s[12:15], s53 offen
  buffer_load_dword v228, v36, s[12:15], s54 offen
  buffer_load_dword v229, v36, s[12:15], s55 offen
  buffer_load_dword v230, v36, s[12:15], s56 offen
  buffer_load_dword v231, v36, s[12:15], s57 offen
  buffer_load_dword v232, v36, s[12:15], s58 offen
  buffer_load_dword v233, v36, s[12:15], s59 offen
  buffer_load_dword v234, v36, s[12:15], s60 offen
  buffer_load_dword v235, v36, s[12:15], s61 offen
  buffer_load_dword v236, v36, s[12:15], s62 offen
  buffer_load_dword v237, v36, s[12:15], s63 offen
  buffer_load_dword v238, v36, s[12:15], s64 offen
  buffer_load_dword v239, v36, s[12:15], s65 offen
  buffer_load_dword v240, v36, s[12:15], s66 offen
  buffer_load_dword v241, v36, s[12:15], s67 offen
  buffer_load_dword v242, v36, s[12:15], s68 offen
  buffer_load_dword v243, v36, s[12:15], s69 offen
  buffer_load_dword v244, v36, s[12:15], s70 offen
  buffer_load_dword v245, v36, s[12:15], s71 offen
  buffer_load_dword v246, v36, s[12:15], s72 offen
  buffer_load_dword v247, v36, s[12:15], s73 offen
  buffer_load_dword v248, v36, s[12:15], s74 offen
  buffer_load_dword v249, v36, s[12:15], s75 offen
  buffer_load_dword v250, v36, s[12:15], s76 offen
  buffer_load_dword v251, v36, s[12:15], s77 offen
  buffer_load_dword v252, v36, s[12:15], s78 offen
  buffer_load_dword v253, v36, s[12:15], s79 offen
  buffer_load_dword v254, v36, s[12:15], s80 offen
  buffer_load_dword v255, v36, s[12:15], s81 offen
  s_mov_b32 s14, 0x400000
  s_mov_b64 s[12:13], s[84:85]
  buffer_load_dword a128, v36, s[12:15], s50 offen
  buffer_load_dword a129, v36, s[12:15], s51 offen
  buffer_load_dword a130, v36, s[12:15], s52 offen
  buffer_load_dword a131, v36, s[12:15], s53 offen
  buffer_load_dword a132, v36, s[12:15], s54 offen
  buffer_load_dword a133, v36, s[12:15], s55 offen
  buffer_load_dword a134, v36, s[12:15], s56 offen
  buffer_load_dword a135, v36, s[12:15], s57 offen
  buffer_load_dword a136, v36, s[12:15], s58 offen
  buffer_load_dword a137, v36, s[12:15], s59 offen
  buffer_load_dword a138, v36, s[12:15], s60 offen
  buffer_load_dword a139, v36, s[12:15], s61 offen
  buffer_load_dword a140, v36, s[12:15], s62 offen
  buffer_load_dword a141, v36, s[12:15], s63 offen
  buffer_load_dword a142, v36, s[12:15], s64 offen
  buffer_load_dword a143, v36, s[12:15], s65 offen
  buffer_load_dword a144, v36, s[12:15], s66 offen
  buffer_load_dword a145, v36, s[12:15], s67 offen
  buffer_load_dword a146, v36, s[12:15], s68 offen
  buffer_load_dword a147, v36, s[12:15], s69 offen
  buffer_load_dword a148, v36, s[12:15], s70 offen
  buffer_load_dword a149, v36, s[12:15], s71 offen
  buffer_load_dword a150, v36, s[12:15], s72 offen
  buffer_load_dword a151, v36, s[12:15], s73 offen
  buffer_load_dword a152, v36, s[12:15], s74 offen
  buffer_load_dword a153, v36, s[12:15], s75 offen
  buffer_load_dword a154, v36, s[12:15], s76 offen
  buffer_load_dword a155, v36, s[12:15], s77 offen
  buffer_load_dword a156, v36, s[12:15], s78 offen
  buffer_load_dword a157, v36, s[12:15], s79 offen
  buffer_load_dword a158, v36, s[12:15], s80 offen
  buffer_load_dword a159, v36, s[12:15], s81 offen
  s_add_u32 s12, s12, 0x100000
  s_addc_u32 s13, s13, 0
  s_sub_u32 s14, s14, 0x100000
  buffer_load_dword a160, v36, s[12:15], s50 offen
  buffer_load_dword a161, v36, s[12:15], s51 offen
  buffer_load_dword a162, v36, s[12:15], s52 offen
  buffer_load_dword a163, v36, s[12:15], s53 offen
  buffer_load_dword a164, v36, s[12:15], s54 offen
  buffer_load_dword a165, v36, s[12:15], s55 offen
  buffer_load_dword a166, v36, s[12:15], s56 offen
  buffer_load_dword a167, v36, s[12:15], s57 offen
  buffer_load_dword a168, v36, s[12:15], s58 offen
  buffer_load_dword a169, v36, s[12:15], s59 offen
  buffer_load_dword a170, v36, s[12:15], s60 offen
  buffer_load_dword a171, v36, s[12:15], s61 offen
  buffer_load_dword a172, v36, s[12:15], s62 offen
  buffer_load_dword a173, v36, s[12:15], s63 offen
  buffer_load_dword a174, v36, s[12:15], s64 offen
  buffer_load_dword a175, v36, s[12:15], s65 offen
  buffer_load_dword a176, v36, s[12:15], s66 offen
  buffer_load_dword a177, v36, s[12:15], s67 offen
  buffer_load_dword a178, v36, s[12:15], s68 offen
  buffer_load_dword a179, v36, s[12:15], s69 offen
  buffer_load_dword a180, v36, s[12:15], s70 offen
  buffer_load_dword a181, v36, s[12:15], s71 offen
  buffer_load_dword a182, v36, s[12:15], s72 offen
  buffer_load_dword a183, v36, s[12:15], s73 offen
  buffer_load_dword a184, v36, s[12:15], s74 offen
  buffer_load_dword a185, v36, s[12:15], s75 offen
  buffer_load_dword a186, v36, s[12:15], s76 offen
  buffer_load_dword a187, v36, s[12:15], s77 offen
  buffer_load_dword a188, v36, s[12:15], s78 offen
  buffer_load_dword a189, v36, s[12:15], s79 offen
  buffer_load_dword a190, v36, s[12:15], s80 offen
  buffer_load_dword a191, v36, s[12:15], s81 offen
  s_add_u32 s12, s12, 0x100000
  s_addc_u32 s13, s13, 0
  s_sub_u32 s14, s14, 0x100000
  buffer_load_dword a192, v36, s[12:15], s50 offen
  buffer_load_dword a193, v36, s[12:15], s51 offen
  s_waitcnt vmcnt(60)
  ds_write_b128 v4, v[128:131] offset:16384
  buffer_load_dword a194, v36, s[12:15], s52 offen
  buffer_load_dword a195, v36, s[12:15], s53 offen
  ds_write_b128 v4, v[132:135] offset:17408
  buffer_load_dword a196, v36, s[12:15], s54 offen
  buffer_load_dword a197, v36, s[12:15], s55 offen
  ds_write_b128 v4, v[136:139] offset:18432
  buffer_load_dword a198, v36, s[12:15], s56 offen
  buffer_load_dword a199, v36, s[12:15], s57 offen
  ds_write_b128 v4, v[140:143] offset:19456
  buffer_load_dword a200, v36, s[12:15], s58 offen
  buffer_load_dword a201, v36, s[12:15], s59 offen
  ds_write_b128 v4, v[144:147] offset:20480
  buffer_load_dword a202, v36, s[12:15], s60 offen
  buffer_load_dword a203, v36, s[12:15], s61 offen
  ds_write_b128 v4, v[148:151] offset:21504
  buffer_load_dword a204, v36, s[12:15], s62 offen
  buffer_load_dword a205, v36, s[12:15], s63 offen
  ds_write_b128 v4, v[152:155] offset:22528
  buffer_load_dword a206, v36, s[12:15], s64 offen
  buffer_load_dword a207, v36, s[12:15], s65 offen
  ds_write_b128 v4, v[156:159] offset:23552
  buffer_load_dword a208, v36, s[12:15], s66 offen
  buffer_load_dword a209, v36, s[12:15], s67 offen
  ds_write_b128 v4, v[160:163] offset:24576
  buffer_load_dword a210, v36, s[12:15], s68 offen
  buffer_load_dword a211, v36, s[12:15], s69 offen
  ds_write_b128 v4, v[164:167] offset:25600
  buffer_load_dword a212, v36, s[12:15], s70 offen
  buffer_load_dword a213, v36, s[12:15], s71 offen
  ds_write_b128 v4, v[168:171] offset:26624
  buffer_load_dword a214, v36, s[12:15], s72 offen
  buffer_load_dword a215, v36, s[12:15], s73 offen
  ds_write_b128 v4, v[172:175] offset:27648
  buffer_load_dword a216, v36, s[12:15], s74 offen
  buffer_load_dword a217, v36, s[12:15], s75 offen
  ds_write_b128 v4, v[176:179] offset:28672
  buffer_load_dword a218, v36, s[12:15], s76 offen
  buffer_load_dword a219, v36, s[12:15], s77 offen
  ds_write_b128 v4, v[180:183] offset:29696
  buffer_load_dword a220, v36, s[12:15], s78 offen
  buffer_load_dword a221, v36, s[12:15], s79 offen
  ds_write_b128 v4, v[184:187] offset:30720
  buffer_load_dword a222, v36, s[12:15], s80 offen
  buffer_load_dword a223, v36, s[12:15], s81 offen
  ds_write_b128 v4, v[188:191] offset:31744
  s_add_u32 s12, s12, 0x100000
  s_addc_u32 s13, s13, 0
  s_sub_u32 s14, s14, 0x100000
  buffer_load_dword a224, v36, s[12:15], s50 offen
  buffer_load_dword a225, v36, s[12:15], s51 offen
  ds_write_b128 v4, v[192:195] offset:0
  buffer_load_dword a226, v36, s[12:15], s52 offen
  buffer_load_dword a227, v36, s[12:15], s53 offen
  ds_write_b128 v4, v[196:199] offset:1024
  buffer_load_dword a228, v36, s[12:15], s54 offen
  buffer_load_dword a229, v36, s[12:15], s55 offen
  ds_write_b128 v4, v[200:203] offset:2048
  buffer_load_dword a230, v36, s[12:15], s56 offen
  buffer_load_dword a231, v36, s[12:15], s57 offen
  ds_write_b128 v4, v[204:207] offset:3072
  buffer_load_dword a232, v36, s[12:15], s58 offen
  buffer_load_dword a233, v36, s[12:15], s59 offen
  ds_write_b128 v4, v[208:211] offset:4096
  buffer_load_dword a234, v36, s[12:15], s60 offen
  buffer_load_dword a235, v36, s[12:15], s61 offen
  ds_write_b128 v4, v[212:215] offset:5120
  buffer_load_dword a236, v36, s[12:15], s62 offen
  buffer_load_dword a237, v36, s[12:15], s63 offen
  ds_write_b128 v4, v[216:219] offset:6144
  buffer_load_dword a238, v36, s[12:15], s64 offen
  buffer_load_dword a239, v36, s[12:15], s65 offen
  ds_write_b128 v4, v[220:223] offset:7168
  buffer_load_dword a240, v36, s[12:15], s66 offen
  buffer_load_dword a241, v36, s[12:15], s67 offen
  ds_write_b128 v4, v[224:227] offset:8192
  buffer_load_dword a242, v36, s[12:15], s68 offen
  buffer_load_dword a243, v36, s[12:15], s69 offen
  ds_write_b128 v4, v[228:231] offset:9216
  buffer_load_dword a244, v36, s[12:15], s70 offen
  buffer_load_dword a245, v36, s[12:15], s71 offen
  ds_write_b128 v4, v[232:235] offset:10240
  buffer_load_dword a246, v36, s[12:15], s72 offen
  buffer_load_dword a247, v36, s[12:15], s73 offen
  ds_write_b128 v4, v[236:239] offset:11264
  buffer_load_dword a248, v36, s[12:15], s74 offen
  buffer_load_dword a249, v36, s[12:15], s75 offen
  ds_write_b128 v4, v[240:243] offset:12288
  buffer_load_dword a250, v36, s[12:15], s76 offen
  buffer_load_dword a251, v36, s[12:15], s77 offen
  ds_write_b128 v4, v[244:247] offset:13312
  buffer_load_dword a252, v36, s[12:15], s78 offen
  buffer_load_dword a253, v36, s[12:15], s79 offen
  ds_write_b128 v4, v[248:251] offset:14336
  buffer_load_dword a254, v36, s[12:15], s80 offen
  buffer_load_dword a255, v36, s[12:15], s81 offen
  ds_write_b128 v4, v[252:255] offset:15360
  s_mov_b32 s14, 0x400000
  s_waitcnt lgkmcnt(0)
  v_mov_b32 v104, 4
  v_mov_b32 v105, 589824
  global_load_dword v106, v104, s[10:11] sc1
  global_load_dword v107, v105, s[8:9] sc1
  s_mov_b64 s[12:13], s[86:87]
  buffer_load_dword v128, v36, s[12:15], s50 offen
  buffer_load_dword v129, v36, s[12:15], s51 offen
  buffer_load_dword v130, v36, s[12:15], s52 offen
  buffer_load_dword v131, v36, s[12:15], s53 offen
  buffer_load_dword v132, v36, s[12:15], s54 offen
  buffer_load_dword v133, v36, s[12:15], s55 offen
  buffer_load_dword v134, v36, s[12:15], s56 offen
  buffer_load_dword v135, v36, s[12:15], s57 offen
  buffer_load_dword v136, v36, s[12:15], s58 offen
  buffer_load_dword v137, v36, s[12:15], s59 offen
  buffer_load_dword v138, v36, s[12:15], s60 offen
  buffer_load_dword v139, v36, s[12:15], s61 offen
  buffer_load_dword v140, v36, s[12:15], s62 offen
  buffer_load_dword v141, v36, s[12:15], s63 offen
  buffer_load_dword v142, v36, s[12:15], s64 offen
  buffer_load_dword v143, v36, s[12:15], s65 offen
  buffer_load_dword v144, v36, s[12:15], s66 offen
  buffer_load_dword v145, v36, s[12:15], s67 offen
  buffer_load_dword v146, v36, s[12:15], s68 offen
  buffer_load_dword v147, v36, s[12:15], s69 offen
  buffer_load_dword v148, v36, s[12:15], s70 offen
  buffer_load_dword v149, v36, s[12:15], s71 offen
  buffer_load_dword v150, v36, s[12:15], s72 offen
  buffer_load_dword v151, v36, s[12:15], s73 offen
  buffer_load_dword v152, v36, s[12:15], s74 offen
  buffer_load_dword v153, v36, s[12:15], s75 offen
  buffer_load_dword v154, v36, s[12:15], s76 offen
  buffer_load_dword v155, v36, s[12:15], s77 offen
  buffer_load_dword v156, v36, s[12:15], s78 offen
  buffer_load_dword v157, v36, s[12:15], s79 offen
  buffer_load_dword v158, v36, s[12:15], s80 offen
  buffer_load_dword v159, v36, s[12:15], s81 offen
  s_add_u32 s12, s12, 0x100000
  s_addc_u32 s13, s13, 0
  s_sub_u32 s14, s14, 0x100000
  buffer_load_dword v160, v36, s[12:15], s50 offen
  buffer_load_dword v161, v36, s[12:15], s51 offen
  buffer_load_dword v162, v36, s[12:15], s52 offen
  buffer_load_dword v163, v36, s[12:15], s53 offen
  buffer_load_dword v164, v36, s[12:15], s54 offen
  buffer_load_dword v165, v36, s[12:15], s55 offen
  buffer_load_dword v166, v36, s[12:15], s56 offen
  buffer_load_dword v167, v36, s[12:15], s57 offen
  buffer_load_dword v168, v36, s[12:15], s58 offen
  buffer_load_dword v169, v36, s[12:15], s59 offen
  buffer_load_dword v170, v36, s[12:15], s60 offen
  buffer_load_dword v171, v36, s[12:15], s61 offen
  buffer_load_dword v172, v36, s[12:15], s62 offen
  buffer_load_dword v173, v36, s[12:15], s63 offen
  buffer_load_dword v174, v36, s[12:15], s64 offen
  buffer_load_dword v175, v36, s[12:15], s65 offen
  buffer_load_dword v176, v36, s[12:15], s66 offen
  buffer_load_dword v177, v36, s[12:15], s67 offen
  buffer_load_dword v178, v36, s[12:15], s68 offen
  buffer_load_dword v179, v36, s[12:15], s69 offen
  buffer_load_dword v180, v36, s[12:15], s70 offen
  buffer_load_dword v181, v36, s[12:15], s71 offen
  buffer_load_dword v182, v36, s[12:15], s72 offen
  buffer_load_dword v183, v36, s[12:15], s73 offen
  buffer_load_dword v184, v36, s[12:15], s74 offen
  buffer_load_dword v185, v36, s[12:15], s75 offen
  buffer_load_dword v186, v36, s[12:15], s76 offen
  buffer_load_dword v187, v36, s[12:15], s77 offen
  buffer_load_dword v188, v36, s[12:15], s78 offen
  buffer_load_dword v189, v36, s[12:15], s79 offen
  buffer_load_dword v190, v36, s[12:15], s80 offen
  buffer_load_dword v191, v36, s[12:15], s81 offen
  s_add_u32 s12, s12, 0x100000
  s_addc_u32 s13, s13, 0
  s_sub_u32 s14, s14, 0x100000
  buffer_load_dword v192, v36, s[12:15], s50 offen
  buffer_load_dword v193, v36, s[12:15], s51 offen
  buffer_load_dword v194, v36, s[12:15], s52 offen
  buffer_load_dword v195, v36, s[12:15], s53 offen
  buffer_load_dword v196, v36, s[12:15], s54 offen
  buffer_load_dword v197, v36, s[12:15], s55 offen
  buffer_load_dword v198, v36, s[12:15], s56 offen
  buffer_load_dword v199, v36, s[12:15], s57 offen
  s_waitcnt vmcnt(60)
  v_readfirstlane_b32 s40, v106
  v_readfirstlane_b32 s41, v107
  s_cmp_ge_u32 s40, 32
  s_cselect_b32 s40, s41, 0
  s_cmp_ge_u32 s40, 128
  s_cbranch_scc0 L_c_nok0_0
  s_add_u32 m0, s43, 8192
  s_mov_b32 s42, 1
  global_load_lds_dwordx4 v14, s[20:21] sc1
  global_load_lds_dwordx4 v14, s[20:21] offset:1024 sc1
L_c_nok0_0:
  buffer_load_dword v200, v36, s[12:15], s58 offen
  buffer_load_dword v201, v36, s[12:15], s59 offen
  buffer_load_dword v202, v36, s[12:15], s60 offen
  buffer_load_dword v203, v36, s[12:15], s61 offen
  buffer_load_dword v204, v36, s[12:15], s62 offen
  buffer_load_dword v205, v36, s[12:15], s63 offen
  buffer_load_dword v206, v36, s[12:15], s64 offen
  buffer_load_dword v207, v36, s[12:15], s65 offen
  buffer_load_dword v208, v36, s[12:15], s66 offen
  buffer_load_dword v209, v36, s[12:15], s67 offen
  buffer_load_dword v210, v36, s[12:15], s68 offen
  buffer_load_dword v211, v36, s[12:15], s69 offen
  buffer_load_dword v212, v36, s[12:15], s70 offen
  buffer_load_dword v213, v36, s[12:15], s71 offen
  buffer_load_dword v214, v36, s[12:15], s72 offen
  buffer_load_dword v215, v36, s[12:15], s73 offen
  buffer_load_dword v216, v36, s[12:15], s74 offen
  buffer_load_dword v217, v36, s[12:15], s75 offen
  buffer_load_dword v218, v36, s[12:15], s76 offen
  buffer_load_dword v219, v36, s[12:15], s77 offen
  buffer_load_dword v220, v36, s[12:15], s78 offen
  buffer_load_dword v221, v36, s[12:15], s79 offen
  buffer_load_dword v222, v36, s[12:15], s80 offen
  buffer_load_dword v223, v36, s[12:15], s81 offen
  s_add_u32 s12, s12, 0x100000
  s_addc_u32 s13, s13, 0
  s_sub_u32 s14, s14, 0x100000
  buffer_load_dword v224, v36, s[12:15], s50 offen
  buffer_load_dword v225, v36, s[12:15], s51 offen
  buffer_load_dword v226, v36, s[12:15], s52 offen
  buffer_load_dword v227, v36, s[12:15], s53 offen
  buffer_load_dword v228, v36, s[12:15], s54 offen
  buffer_load_dword v229, v36, s[12:15], s55 offen
  buffer_load_dword v230, v36, s[12:15], s56 offen
  buffer_load_dword v231, v36, s[12:15], s57 offen
  buffer_load_dword v232, v36, s[12:15], s58 offen
  buffer_load_dword v233, v36, s[12:15], s59 offen
  buffer_load_dword v234, v36, s[12:15], s60 offen
  buffer_load_dword v235, v36, s[12:15], s61 offen
  buffer_load_dword v236, v36, s[12:15], s62 offen
  buffer_load_dword v237, v36, s[12:15], s63 offen
  buffer_load_dword v238, v36, s[12:15], s64 offen
  buffer_load_dword v239, v36, s[12:15], s65 offen
  buffer_load_dword v240, v36, s[12:15], s66 offen
  buffer_load_dword v241, v36, s[12:15], s67 offen
  buffer_load_dword v242, v36, s[12:15], s68 offen
  buffer_load_dword v243, v36, s[12:15], s69 offen
  buffer_load_dword v244, v36, s[12:15], s70 offen
  buffer_load_dword v245, v36, s[12:15], s71 offen
  buffer_load_dword v246, v36, s[12:15], s72 offen
  buffer_load_dword v247, v36, s[12:15], s73 offen
  buffer_load_dword v248, v36, s[12:15], s74 offen
  buffer_load_dword v249, v36, s[12:15], s75 offen
  buffer_load_dword v250, v36, s[12:15], s76 offen
  buffer_load_dword v251, v36, s[12:15], s77 offen
  buffer_load_dword v252, v36, s[12:15], s78 offen
  buffer_load_dword v253, v36, s[12:15], s79 offen
  buffer_load_dword v254, v36, s[12:15], s80 offen
  buffer_load_dword v255, v36, s[12:15], s81 offen
  s_mov_b32 s14, 0x400000
  s_branch L_c_wld
L_c_wl1:
  s_cmp_eq_u32 s4, 1
  s_cbranch_scc0 L_c_wl2
  s_nop 0
  s_mov_b64 s[12:13], s[82:83]
  buffer_load_dword v224, v36, s[12:15], s50 offen
  buffer_load_dword v225, v36, s[12:15], s51 offen
  buffer_load_dword v226, v36, s[12:15], s52 offen
  buffer_load_dword v227, v36, s[12:15], s53 offen
  buffer_load_dword v228, v36, s[12:15], s54 offen
  buffer_load_dword v229, v36, s[12:15], s55 offen
  buffer_load_dword v230, v36, s[12:15], s56 offen
  buffer_load_dword v231, v36, s[12:15], s57 offen
  buffer_load_dword v232, v36, s[12:15], s58 offen
  buffer_load_dword v233, v36, s[12:15], s59 offen
  buffer_load_dword v234, v36, s[12:15], s60 offen
  buffer_load_dword v235, v36, s[12:15], s61 offen
  buffer_load_dword v236, v36, s[12:15], s62 offen
  buffer_load_dword v237, v36, s[12:15], s63 offen
  buffer_load_dword v238, v36, s[12:15], s64 offen
  buffer_load_dword v239, v36, s[12:15], s65 offen
  buffer_load_dword v240, v36, s[12:15], s66 offen
  buffer_load_dword v241, v36, s[12:15], s67 offen
  buffer_load_dword v242, v36, s[12:15], s68 offen
  buffer_load_dword v243, v36, s[12:15], s69 offen
  buffer_load_dword v244, v36, s[12:15], s70 offen
  buffer_load_dword v245, v36, s[12:15], s71 offen
  buffer_load_dword v246, v36, s[12:15], s72 offen
  buffer_load_dword v247, v36, s[12:15], s73 offen
  buffer_load_dword v248, v36, s[12:15], s74 offen
  buffer_load_dword v249, v36, s[12:15], s75 offen
  buffer_load_dword v250, v36, s[12:15], s76 offen
  buffer_load_dword v251, v36, s[12:15], s77 offen
  buffer_load_dword v252, v36, s[12:15], s78 offen
  buffer_load_dword v253, v36, s[12:15], s79 offen
  buffer_load_dword v254, v36, s[12:15], s80 offen
  buffer_load_dword v255, v36, s[12:15], s81 offen
  s_add_u32 s12, s12, 0x100000
  s_addc_u32 s13, s13, 0
  s_sub_u32 s14, s14, 0x100000
  buffer_load_dword a0, v36, s[12:15], s50 offen
  buffer_load_dword a1, v36, s[12:15], s51 offen
  buffer_load_dword a2, v36, s[12:15], s52 offen
  buffer_load_dword a3, v36, s[12:15], s53 offen
  buffer_load_dword a4, v36, s[12:15], s54 offen
  buffer_load_dword a5, v36, s[12:15], s55 offen
  buffer_load_dword a6, v36, s[12:15], s56 offen
  buffer_load_dword a7, v36, s[12:15], s57 offen
  buffer_load_dword a8, v36, s[12:15], s58 offen
  buffer_load_dword a9, v36, s[12:15], s59 offen
  buffer_load_dword a10, v36, s[12:15], s60 offen
  buffer_load_dword a11, v36, s[12:15], s61 offen
  buffer_load_dword a12, v36, s[12:15], s62 offen
  buffer_load_dword a13, v36, s[12:15], s63 offen
  buffer_load_dword a14, v36, s[12:15], s64 offen
  buffer_load_dword a15, v36, s[12:15], s65 offen
  buffer_load_dword a16, v36, s[12:15], s66 offen
  buffer_load_dword a17, v36, s[12:15], s67 offen
  buffer_load_dword a18, v36, s[12:15], s68 offen
  buffer_load_dword a19, v36, s[12:15], s69 offen
  buffer_load_dword a20, v36, s[12:15], s70 offen
  buffer_load_dword a21, v36, s[12:15], s71 offen
  buffer_load_dword a22, v36, s[12:15], s72 offen
  buffer_load_dword a23, v36, s[12:15], s73 offen
  buffer_load_dword a24, v36, s[12:15], s74 offen
  buffer_load_dword a25, v36, s[12:15], s75 offen
  buffer_load_dword a26, v36, s[12:15], s76 offen
  buffer_load_dword a27, v36, s[12:15], s77 offen
  buffer_load_dword a28, v36, s[12:15], s78 offen
  buffer_load_dword a29, v36, s[12:15], s79 offen
  buffer_load_dword a30, v36, s[12:15], s80 offen
  buffer_load_dword a31, v36, s[12:15], s81 offen
  s_add_u32 s12, s12, 0x100000
  s_addc_u32 s13, s13, 0
  s_sub_u32 s14, s14, 0x100000
  buffer_load_dword a32, v36, s[12:15], s50 offen
  buffer_load_dword a33, v36, s[12:15], s51 offen
  buffer_load_dword a34, v36, s[12:15], s52 offen
  buffer_load_dword a35, v36, s[12:15], s53 offen
  buffer_load_dword a36, v36, s[12:15], s54 offen
  buffer_load_dword a37, v36, s[12:15], s55 offen
  buffer_load_dword a38, v36, s[12:15], s56 offen
  buffer_load_dword a39, v36, s[12:15], s57 offen
  buffer_load_dword a40, v36, s[12:15], s58 offen
  buffer_load_dword a41, v36, s[12:15], s59 offen
  buffer_load_dword a42, v36, s[12:15], s60 offen
  buffer_load_dword a43, v36, s[12:15], s61 offen
  buffer_load_dword a44, v36, s[12:15], s62 offen
  buffer_load_dword a45, v36, s[12:15], s63 offen
  buffer_load_dword a46, v36, s[12:15], s64 offen
  buffer_load_dword a47, v36, s[12:15], s65 offen
  buffer_load_dword a48, v36, s[12:15], s66 offen
  buffer_load_dword a49, v36, s[12:15], s67 offen
  buffer_load_dword a50, v36, s[12:15], s68 offen
  buffer_load_dword a51, v36, s[12:15], s69 offen
  buffer_load_dword a52, v36, s[12:15], s70 offen
  buffer_load_dword a53, v36, s[12:15], s71 offen
  buffer_load_dword a54, v36, s[12:15], s72 offen
  buffer_load_dword a55, v36, s[12:15], s73 offen
  buffer_load_dword a56, v36, s[12:15], s74 offen
  buffer_load_dword a57, v36, s[12:15], s75 offen
  buffer_load_dword a58, v36, s[12:15], s76 offen
  buffer_load_dword a59, v36, s[12:15], s77 offen
  buffer_load_dword a60, v36, s[12:15], s78 offen
  buffer_load_dword a61, v36, s[12:15], s79 offen
  buffer_load_dword a62, v36, s[12:15], s80 offen
  buffer_load_dword a63, v36, s[12:15], s81 offen
  s_add_u32 s12, s12, 0x100000
  s_addc_u32 s13, s13, 0
  s_sub_u32 s14, s14, 0x100000
  buffer_load_dword v192, v36, s[12:15], s50 offen
  buffer_load_dword v193, v36, s[12:15], s51 offen
  buffer_load_dword v194, v36, s[12:15], s52 offen
  buffer_load_dword v195, v36, s[12:15], s53 offen
  buffer_load_dword v196, v36, s[12:15], s54 offen
  buffer_load_dword v197, v36, s[12:15], s55 offen
  buffer_load_dword v198, v36, s[12:15], s56 offen
  buffer_load_dword v199, v36, s[12:15], s57 offen
  buffer_load_dword v200, v36, s[12:15], s58 offen
  buffer_load_dword v201, v36, s[12:15], s59 offen
  buffer_load_dword v202, v36, s[12:15], s60 offen
  buffer_load_dword v203, v36, s[12:15], s61 offen
  buffer_load_dword v204, v36, s[12:15], s62 offen
  buffer_load_dword v205, v36, s[12:15], s63 offen
  buffer_load_dword v206, v36, s[12:15], s64 offen
  buffer_load_dword v207, v36, s[12:15], s65 offen
  buffer_load_dword v208, v36, s[12:15], s66 offen
  buffer_load_dword v209, v36, s[12:15], s67 offen
  buffer_load_dword v210, v36, s[12:15], s68 offen
  buffer_load_dword v211, v36, s[12:15], s69 offen
  buffer_load_dword v212, v36, s[12:15], s70 offen
  buffer_load_dword v213, v36, s[12:15], s71 offen
  buffer_load_dword v214, v36, s[12:15], s72 offen
  buffer_load_dword v215, v36, s[12:15], s73 offen
  buffer_load_dword v216, v36, s[12:15], s74 offen
  buffer_load_dword v217, v36, s[12:15], s75 offen
  buffer_load_dword v218, v36, s[12:15], s76 offen
  buffer_load_dword v219, v36, s[12:15], s77 offen
  buffer_load_dword v220, v36, s[12:15], s78 offen
  buffer_load_dword v221, v36, s[12:15], s79 offen
  buffer_load_dword v222, v36, s[12:15], s80 offen
  buffer_load_dword v223, v36, s[12:15], s81 offen
  s_mov_b32 s14, 0x400000
  s_mov_b64 s[12:13], s[84:85]
  buffer_load_dword a224, v36, s[12:15], s50 offen
  buffer_load_dword a225, v36, s[12:15], s51 offen
  buffer_load_dword a226, v36, s[12:15], s52 offen
  buffer_load_dword a227, v36, s[12:15], s53 offen
  buffer_load_dword a228, v36, s[12:15], s54 offen
  buffer_load_dword a229, v36, s[12:15], s55 offen
  buffer_load_dword a230, v36, s[12:15], s56 offen
  buffer_load_dword a231, v36, s[12:15], s57 offen
  buffer_load_dword a232, v36, s[12:15], s58 offen
  buffer_load_dword a233, v36, s[12:15], s59 offen
  buffer_load_dword a234, v36, s[12:15], s60 offen
  buffer_load_dword a235, v36, s[12:15], s61 offen
  buffer_load_dword a236, v36, s[12:15], s62 offen
  buffer_load_dword a237, v36, s[12:15], s63 offen
  buffer_load_dword a238, v36, s[12:15], s64 offen
  buffer_load_dword a239, v36, s[12:15], s65 offen
  buffer_load_dword a240, v36, s[12:15], s66 offen
  buffer_load_dword a241, v36, s[12:15], s67 offen
  buffer_load_dword a242, v36, s[12:15], s68 offen
  buffer_load_dword a243, v36, s[12:15], s69 offen
  buffer_load_dword a244, v36, s[12:15], s70 offen
  buffer_load_dword a245, v36, s[12:15], s71 offen
  buffer_load_dword a246, v36, s[12:15], s72 offen
  buffer_load_dword a247, v36, s[12:15], s73 offen
  buffer_load_dword a248, v36, s[12:15], s74 offen
  buffer_load_dword a249, v36, s[12:15], s75 offen
  buffer_load_dword a250, v36, s[12:15], s76 offen
  buffer_load_dword a251, v36, s[12:15], s77 offen
  buffer_load_dword a252, v36, s[12:15], s78 offen
  buffer_load_dword a253, v36, s[12:15], s79 offen
  buffer_load_dword a254, v36, s[12:15], s80 offen
  buffer_load_dword a255, v36, s[12:15], s81 offen
  s_add_u32 s12, s12, 0x100000
  s_addc_u32 s13, s13, 0
  s_sub_u32 s14, s14, 0x100000
  buffer_load_dword a128, v36, s[12:15], s50 offen
  buffer_load_dword a129, v36, s[12:15], s51 offen
  buffer_load_dword a130, v36, s[12:15], s52 offen
  buffer_load_dword a131, v36, s[12:15], s53 offen
  buffer_load_dword a132, v36, s[12:15], s54 offen
  buffer_load_dword a133, v36, s[12:15], s55 offen
  buffer_load_dword a134, v36, s[12:15], s56 offen
  buffer_load_dword a135, v36, s[12:15], s57 offen
  buffer_load_dword a136, v36, s[12:15], s58 offen
  buffer_load_dword a137, v36, s[12:15], s59 offen
  buffer_load_dword a138, v36, s[12:15], s60 offen
  buffer_load_dword a139, v36, s[12:15], s61 offen
  buffer_load_dword a140, v36, s[12:15], s62 offen
  buffer_load_dword a141, v36, s[12:15], s63 offen
  buffer_load_dword a142, v36, s[12:15], s64 offen
  buffer_load_dword a143, v36, s[12:15], s65 offen
  buffer_load_dword a144, v36, s[12:15], s66 offen
  buffer_load_dword a145, v36, s[12:15], s67 offen
  buffer_load_dword a146, v36, s[12:15], s68 offen
  buffer_load_dword a147, v36, s[12:15], s69 offen
  buffer_load_dword a148, v36, s[12:15], s70 offen
  buffer_load_dword a149, v36, s[12:15], s71 offen
  buffer_load_dword a150, v36, s[12:15], s72 offen
  buffer_load_dword a151, v36, s[12:15], s73 offen
  buffer_load_dword a152, v36, s[12:15], s74 offen
  buffer_load_dword a153, v36, s[12:15], s75 offen
  buffer_load_dword a154, v36, s[12:15], s76 offen
  buffer_load_dword a155, v36, s[12:15], s77 offen
  buffer_load_dword a156, v36, s[12:15], s78 offen
  buffer_load_dword a157, v36, s[12:15], s79 offen
  buffer_load_dword a158, v36, s[12:15], s80 offen
  buffer_load_dword a159, v36, s[12:15], s81 offen
  s_add_u32 s12, s12, 0x100000
  s_addc_u32 s13, s13, 0
  s_sub_u32 s14, s14, 0x100000
  buffer_load_dword a160, v36, s[12:15], s50 offen
  buffer_load_dword a161, v36, s[12:15], s51 offen
  s_waitcnt vmcnt(60)
  ds_write_b128 v4, v[128:131] offset:16384
  buffer_load_dword a162, v36, s[12:15], s52 offen
  buffer_load_dword a163, v36, s[12:15], s53 offen
  ds_write_b128 v4, v[132:135] offset:17408
  buffer_load_dword a164, v36, s[12:15], s54 offen
  buffer_load_dword a165, v36, s[12:15], s55 offen
  ds_write_b128 v4, v[136:139] offset:18432
  buffer_load_dword a166, v36, s[12:15], s56 offen
  buffer_load_dword a167, v36, s[12:15], s57 offen
  ds_write_b128 v4, v[140:143] offset:19456
  buffer_load_dword a168, v36, s[12:15], s58 offen
  buffer_load_dword a169, v36, s[12:15], s59 offen
  ds_write_b128 v4, v[144:147] offset:20480
  buffer_load_dword a170, v36, s[12:15], s60 offen
  buffer_load_dword a171, v36, s[12:15], s61 offen
  ds_write_b128 v4, v[148:151] offset:21504
  buffer_load_dword a172, v36, s[12:15], s62 offen
  buffer_load_dword a173, v36, s[12:15], s63 offen
  ds_write_b128 v4, v[152:155] offset:22528
  buffer_load_dword a174, v36, s[12:15], s64 offen
  buffer_load_dword a175, v36, s[12:15], s65 offen
  ds_write_b128 v4, v[156:159] offset:23552
  buffer_load_dword a176, v36, s[12:15], s66 offen
  buffer_load_dword a177, v36, s[12:15], s67 offen
  ds_write_b128 v4, v[160:163] offset:24576
  buffer_load_dword a178, v36, s[12:15], s68 offen
  buffer_load_dword a179, v36, s[12:15], s69 offen
  ds_write_b128 v4, v[164:167] offset:25600
  buffer_load_dword a180, v36, s[12:15], s70 offen
  buffer_load_dword a181, v36, s[12:15], s71 offen
  ds_write_b128 v4, v[168:171] offset:26624
  buffer_load_dword a182, v36, s[12:15], s72 offen
  buffer_load_dword a183, v36, s[12:15], s73 offen
  ds_write_b128 v4, v[172:175] offset:27648
  buffer_load_dword a184, v36, s[12:15], s74 offen
  buffer_load_dword a185, v36, s[12:15], s75 offen
  ds_write_b128 v4, v[176:179] offset:28672
  buffer_load_dword a186, v36, s[12:15], s76 offen
  buffer_load_dword a187, v36, s[12:15], s77 offen
  ds_write_b128 v4, v[180:183] offset:29696
  buffer_load_dword a188, v36, s[12:15], s78 offen
  buffer_load_dword a189, v36, s[12:15], s79 offen
  ds_write_b128 v4, v[184:187] offset:30720
  buffer_load_dword a190, v36, s[12:15], s80 offen
  buffer_load_dword a191, v36, s[12:15], s81 offen
  ds_write_b128 v4, v[188:191] offset:31744
  s_add_u32 s12, s12, 0x100000
  s_addc_u32 s13, s13, 0
  s_sub_u32 s14, s14, 0x100000
  buffer_load_dword a192, v36, s[12:15], s50 offen
  buffer_load_dword a193, v36, s[12:15], s51 offen
  ds_write_b128 v4, v[192:195] offset:0
  buffer_load_dword a194, v36, s[12:15], s52 offen
  buffer_load_dword a195, v36, s[12:15], s53 offen
  ds_write_b128 v4, v[196:199] offset:1024
  buffer_load_dword a196, v36, s[12:15], s54 offen
  buffer_load_dword a197, v36, s[12:15], s55 offen
  ds_write_b128 v4, v[200:203] offset:2048
  buffer_load_dword a198, v36, s[12:15], s56 offen
  buffer_load_dword a199, v36, s[12:15], s57 offen
  ds_write_b128 v4, v[204:207] offset:3072
  buffer_load_dword a200, v36, s[12:15], s58 offen
  buffer_load_dword a201, v36, s[12:15], s59 offen
  ds_write_b128 v4, v[208:211] offset:4096
  buffer_load_dword a202, v36, s[12:15], s60 offen
  buffer_load_dword a203, v36, s[12:15], s61 offen
  ds_write_b128 v4, v[212:215] offset:5120
  buffer_load_dword a204, v36, s[12:15], s62 offen
  buffer_load_dword a205, v36, s[12:15], s63 offen
  ds_write_b128 v4, v[216:219] offset:6144
  buffer_load_dword a206, v36, s[12:15], s64 offen
  buffer_load_dword a207, v36, s[12:15], s65 offen
  ds_write_b128 v4, v[220:223] offset:7168
  buffer_load_dword a208, v36, s[12:15], s66 offen
  buffer_load_dword a209, v36, s[12:15], s67 offen
  ds_write_b128 v4, v[224:227] offset:8192
  buffer_load_dword a210, v36, s[12:15], s68 offen
  buffer_load_dword a211, v36, s[12:15], s69 offen
  ds_write_b128 v4, v[228:231] offset:9216
  buffer_load_dword a212, v36, s[12:15], s70 offen
  buffer_load_dword a213, v36, s[12:15], s71 offen
  ds_write_b128 v4, v[232:235] offset:10240
  buffer_load_dword a214, v36, s[12:15], s72 offen
  buffer_load_dword a215, v36, s[12:15], s73 offen
  ds_write_b128 v4, v[236:239] offset:11264
  buffer_load_dword a216, v36, s[12:15], s74 offen
  buffer_load_dword a217, v36, s[12:15], s75 offen
  ds_write_b128 v4, v[240:243] offset:12288
  buffer_load_dword a218, v36, s[12:15], s76 offen
  buffer_load_dword a219, v36, s[12:15], s77 offen
  ds_write_b128 v4, v[244:247] offset:13312
  buffer_load_dword a220, v36, s[12:15], s78 offen
  buffer_load_dword a221, v36, s[12:15], s79 offen
  ds_write_b128 v4, v[248:251] offset:14336
  buffer_load_dword a222, v36, s[12:15], s80 offen
  buffer_load_dword a223, v36, s[12:15], s81 offen
  ds_write_b128 v4, v[252:255] offset:15360
  s_mov_b32 s14, 0x400000
  s_waitcnt lgkmcnt(0)
  v_mov_b32 v104, 4
  v_mov_b32 v105, 589824
  global_load_dword v106, v104, s[10:11] sc1
  global_load_dword v107, v105, s[8:9] sc1
  s_mov_b64 s[12:13], s[86:87]
  buffer_load_dword v224, v36, s[12:15], s50 offen
  buffer_load_dword v225, v36, s[12:15], s51 offen
  buffer_load_dword v226, v36, s[12:15], s52 offen
  buffer_load_dword v227, v36, s[12:15], s53 offen
  buffer_load_dword v228, v36, s[12:15], s54 offen
  buffer_load_dword v229, v36, s[12:15], s55 offen
  buffer_load_dword v230, v36, s[12:15], s56 offen
  buffer_load_dword v231, v36, s[12:15], s57 offen
  buffer_load_dword v232, v36, s[12:15], s58 offen
  buffer_load_dword v233, v36, s[12:15], s59 offen
  buffer_load_dword v234, v36, s[12:15], s60 offen
  buffer_load_dword v235, v36, s[12:15], s61 offen
  buffer_load_dword v236, v36, s[12:15], s62 offen
  buffer_load_dword v237, v36, s[12:15], s63 offen
  buffer_load_dword v238, v36, s[12:15], s64 offen
  buffer_load_dword v239, v36, s[12:15], s65 offen
  buffer_load_dword v240, v36, s[12:15], s66 offen
  buffer_load_dword v241, v36, s[12:15], s67 offen
  buffer_load_dword v242, v36, s[12:15], s68 offen
  buffer_load_dword v243, v36, s[12:15], s69 offen
  buffer_load_dword v244, v36, s[12:15], s70 offen
  buffer_load_dword v245, v36, s[12:15], s71 offen
  buffer_load_dword v246, v36, s[12:15], s72 offen
  buffer_load_dword v247, v36, s[12:15], s73 offen
  buffer_load_dword v248, v36, s[12:15], s74 offen
  buffer_load_dword v249, v36, s[12:15], s75 offen
  buffer_load_dword v250, v36, s[12:15], s76 offen
  buffer_load_dword v251, v36, s[12:15], s77 offen
  buffer_load_dword v252, v36, s[12:15], s78 offen
  buffer_load_dword v253, v36, s[12:15], s79 offen
  buffer_load_dword v254, v36, s[12:15], s80 offen
  buffer_load_dword v255, v36, s[12:15], s81 offen
  s_add_u32 s12, s12, 0x100000
  s_addc_u32 s13, s13, 0
  s_sub_u32 s14, s14, 0x100000
  buffer_load_dword v128, v36, s[12:15], s50 offen
  buffer_load_dword v129, v36, s[12:15], s51 offen
  buffer_load_dword v130, v36, s[12:15], s52 offen
  buffer_load_dword v131, v36, s[12:15], s53 offen
  buffer_load_dword v132, v36, s[12:15], s54 offen
  buffer_load_dword v133, v36, s[12:15], s55 offen
  buffer_load_dword v134, v36, s[12:15], s56 offen
  buffer_load_dword v135, v36, s[12:15], s57 offen
  buffer_load_dword v136, v36, s[12:15], s58 offen
  buffer_load_dword v137, v36, s[12:15], s59 offen
  buffer_load_dword v138, v36, s[12:15], s60 offen
  buffer_load_dword v139, v36, s[12:15], s61 offen
  buffer_load_dword v140, v36, s[12:15], s62 offen
  buffer_load_dword v141, v36, s[12:15], s63 offen
  buffer_load_dword v142, v36, s[12:15], s64 offen
  buffer_load_dword v143, v36, s[12:15], s65 offen
  buffer_load_dword v144, v36, s[12:15], s66 offen
  buffer_load_dword v145, v36, s[12:15], s67 offen
  buffer_load_dword v146, v36, s[12:15], s68 offen
  buffer_load_dword v147, v36, s[12:15], s69 offen
  buffer_load_dword v148, v36, s[12:15], s70 offen
  buffer_load_dword v149, v36, s[12:15], s71 offen
  buffer_load_dword v150, v36, s[12:15], s72 offen
  buffer_load_dword v151, v36, s[12:15], s73 offen
  buffer_load_dword v152, v36, s[12:15], s74 offen
  buffer_load_dword v153, v36, s[12:15], s75 offen
  buffer_load_dword v154, v36, s[12:15], s76 offen
  buffer_load_dword v155, v36, s[12:15], s77 offen
  buffer_load_dword v156, v36, s[12:15], s78 offen
  buffer_load_dword v157, v36, s[12:15], s79 offen
  buffer_load_dword v158, v36, s[12:15], s80 offen
  buffer_load_dword v159, v36, s[12:15], s81 offen
  s_add_u32 s12, s12, 0x100000
  s_addc_u32 s13, s13, 0
  s_sub_u32 s14, s14, 0x100000
  buffer_load_dword v160, v36, s[12:15], s50 offen
  buffer_load_dword v161, v36, s[12:15], s51 offen
  buffer_load_dword v162, v36, s[12:15], s52 offen
  buffer_load_dword v163, v36, s[12:15], s53 offen
  buffer_load_dword v164, v36, s[12:15], s54 offen
  buffer_load_dword v165, v36, s[12:15], s55 offen
  buffer_load_dword v166, v36, s[12:15], s56 offen
  buffer_load_dword v167, v36, s[12:15], s57 offen
  s_waitcnt vmcnt(60)
  v_readfirstlane_b32 s40, v106
  v_readfirstlane_b32 s41, v107
  s_cmp_ge_u32 s40, 32
  s_cselect_b32 s40, s41, 0
  s_cmp_ge_u32 s40, 128
  s_cbranch_scc0 L_c_nok0_1
  s_add_u32 m0, s43, 8192
  s_mov_b32 s42, 1
  global_load_lds_dwordx4 v14, s[20:21] sc1
  global_load_lds_dwordx4 v14, s[20:21] offset:1024 sc1
L_c_nok0_1:
  buffer_load_dword v168, v36, s[12:15], s58 offen
  buffer_load_dword v169, v36, s[12:15], s59 offen
  buffer_load_dword v170, v36, s[12:15], s60 offen
  buffer_load_dword v171, v36, s[12:15], s61 offen
  buffer_load_dword v172, v36, s[12:15], s62 offen
  buffer_load_dword v173, v36, s[12:15], s63 offen
  buffer_load_dword v174, v36, s[12:15], s64 offen
  buffer_load_dword v175, v36, s[12:15], s65 offen
  buffer_load_dword v176, v36, s[12:15], s66 offen
  buffer_load_dword v177, v36, s[12:15], s67 offen
  buffer_load_dword v178, v36, s[12:15], s68 offen
  buffer_load_dword v179, v36, s[12:15], s69 offen
  buffer_load_dword v180, v36, s[12:15], s70 offen
  buffer_load_dword v181, v36, s[12:15], s71 offen
  buffer_load_dword v182, v36, s[12:15], s72 offen
  buffer_load_dword v183, v36, s[12:15], s73 offen
  buffer_load_dword v184, v36, s[12:15], s74 offen
  buffer_load_dword v185, v36, s[12:15], s75 offen
  buffer_load_dword v186, v36, s[12:15], s76 offen
  buffer_load_dword v187, v36, s[12:15], s77 offen
  buffer_load_dword v188, v36, s[12:15], s78 offen
  buffer_load_dword v189, v36, s[12:15], s79 offen
  buffer_load_dword v190, v36, s[12:15], s80 offen
  buffer_load_dword v191, v36, s[12:15], s81 offen
  s_add_u32 s12, s12, 0x100000
  s_addc_u32 s13, s13, 0
  s_sub_u32 s14, s14, 0x100000
  buffer_load_dword v192, v36, s[12:15], s50 offen
  buffer_load_dword v193, v36, s[12:15], s51 offen
  buffer_load_dword v194, v36, s[12:15], s52 offen
  buffer_load_dword v195, v36, s[12:15], s53 offen
  buffer_load_dword v196, v36, s[12:15], s54 offen
  buffer_load_dword v197, v36, s[12:15], s55 offen
  buffer_load_dword v198, v36, s[12:15], s56 offen
  buffer_load_dword v199, v36, s[12:15], s57 offen
  buffer_load_dword v200, v36, s[12:15], s58 offen
  buffer_load_dword v201, v36, s[12:15], s59 offen
  buffer_load_dword v202, v36, s[12:15], s60 offen
  buffer_load_dword v203, v36, s[12:15], s61 offen
  buffer_load_dword v204, v36, s[12:15], s62 offen
  buffer_load_dword v205, v36, s[12:15], s63 offen
  buffer_load_dword v206, v36, s[12:15], s64 offen
  buffer_load_dword v207, v36, s[12:15], s65 offen
  buffer_load_dword v208, v36, s[12:15], s66 offen
  buffer_load_dword v209, v36, s[12:15], s67 offen
  buffer_load_dword v210, v36, s[12:15], s68 offen
  buffer_load_dword v211, v36, s[12:15], s69 offen
  buffer_load_dword v212, v36, s[12:15], s70 offen
  buffer_load_dword v213, v36, s[12:15], s71 offen
  buffer_load_dword v214, v36, s[12:15], s72 offen
  buffer_load_dword v215, v36, s[12:15], s73 offen
  buffer_load_dword v216, v36, s[12:15], s74 offen
  buffer_load_dword v217, v36, s[12:15], s75 offen
  buffer_load_dword v218, v36, s[12:15], s76 offen
  buffer_load_dword v219, v36, s[12:15], s77 offen
  buffer_load_dword v220, v36, s[12:15], s78 offen
  buffer_load_dword v221, v36, s[12:15], s79 offen
  buffer_load_dword v222, v36, s[12:15], s80 offen
  buffer_load_dword v223, v36, s[12:15], s81 offen
  s_mov_b32 s14, 0x400000
  s_branch L_c_wld
L_c_wl2:
  s_cmp_eq_u32 s4, 2
  s_cbranch_scc0 L_c_wl3
  s_nop 0
  s_mov_b64 s[12:13], s[82:83]
  buffer_load_dword v192, v36, s[12:15], s50 offen
  buffer_load_dword v193, v36, s[12:15], s51 offen
  buffer_load_dword v194, v36, s[12:15], s52 offen
  buffer_load_dword v195, v36, s[12:15], s53 offen
  buffer_load_dword v196, v36, s[12:15], s54 offen
  buffer_load_dword v197, v36, s[12:15], s55 offen
  buffer_load_dword v198, v36, s[12:15], s56 offen
  buffer_load_dword v199, v36, s[12:15], s57 offen
  buffer_load_dword v200, v36, s[12:15], s58 offen
  buffer_load_dword v201, v36, s[12:15], s59 offen
  buffer_load_dword v202, v36, s[12:15], s60 offen
  buffer_load_dword v203, v36, s[12:15], s61 offen
  buffer_load_dword v204, v36, s[12:15], s62 offen
  buffer_load_dword v205, v36, s[12:15], s63 offen
  buffer_load_dword v206, v36, s[12:15], s64 offen
  buffer_load_dword v207, v36, s[12:15], s65 offen
  buffer_load_dword v208, v36, s[12:15], s66 offen
  buffer_load_dword v209, v36, s[12:15], s67 offen
  buffer_load_dword v210, v36, s[12:15], s68 offen
  buffer_load_dword v211, v36, s[12:15], s69 offen
  buffer_load_dword v212, v36, s[12:15], s70 offen
  buffer_load_dword v213, v36, s[12:15], s71 offen
  buffer_load_dword v214, v36, s[12:15], s72 offen
  buffer_load_dword v215, v36, s[12:15], s73 offen
  buffer_load_dword v216, v36, s[12:15], s74 offen
  buffer_load_dword v217, v36, s[12:15], s75 offen
  buffer_load_dword v218, v36, s[12:15], s76 offen
  buffer_load_dword v219, v36, s[12:15], s77 offen
  buffer_load_dword v220, v36, s[12:15], s78 offen
  buffer_load_dword v221, v36, s[12:15], s79 offen
  buffer_load_dword v222, v36, s[12:15], s80 offen
  buffer_load_dword v223, v36, s[12:15], s81 offen
  s_add_u32 s12, s12, 0x100000
  s_addc_u32 s13, s13, 0
  s_sub_u32 s14, s14, 0x100000
  buffer_load_dword v224, v36, s[12:15], s50 offen
  buffer_load_dword v225, v36, s[12:15], s51 offen
  buffer_load_dword v226, v36, s[12:15], s52 offen
  buffer_load_dword v227, v36, s[12:15], s53 offen
  buffer_load_dword v228, v36, s[12:15], s54 offen
  buffer_load_dword v229, v36, s[12:15], s55 offen
  buffer_load_dword v230, v36, s[12:15], s56 offen
  buffer_load_dword v231, v36, s[12:15], s57 offen
  buffer_load_dword v232, v36, s[12:15], s58 offen
  buffer_load_dword v233, v36, s[12:15], s59 offen
  buffer_load_dword v234, v36, s[12:15], s60 offen
  buffer_load_dword v235, v36, s[12:15], s61 offen
  buffer_load_dword v236, v36, s[12:15], s62 offen
  buffer_load_dword v237, v36, s[12:15], s63 offen
  buffer_load_dword v238, v36, s[12:15], s64 offen
  buffer_load_dword v239, v36, s[12:15], s65 offen
  buffer_load_dword v240, v36, s[12:15], s66 offen
  buffer_load_dword v241, v36, s[12:15], s67 offen
  buffer_load_dword v242, v36, s[12:15], s68 offen
  buffer_load_dword v243, v36, s[12:15], s69 offen
  buffer_load_dword v244, v36, s[12:15], s70 offen
  buffer_load_dword v245, v36, s[12:15], s71 offen
  buffer_load_dword v246, v36, s[12:15], s72 offen
  buffer_load_dword v247, v36, s[12:15], s73 offen
  buffer_load_dword v248, v36, s[12:15], s74 offen
  buffer_load_dword v249, v36, s[12:15], s75 offen
  buffer_load_dword v250, v36, s[12:15], s76 offen
  buffer_load_dword v251, v36, s[12:15], s77 offen
  buffer_load_dword v252, v36, s[12:15], s78 offen
  buffer_load_dword v253, v36, s[12:15], s79 offen
  buffer_load_dword v254, v36, s[12:15], s80 offen
  buffer_load_dword v255, v36, s[12:15], s81 offen
  s_add_u32 s12, s12, 0x100000
  s_addc_u32 s13, s13, 0
  s_sub_u32 s14, s14, 0x100000
  buffer_load_dword a0, v36, s[12:15], s50 offen
  buffer_load_dword a1, v36, s[12:15], s51 offen
  buffer_load_dword a2, v36, s[12:15], s52 offen
  buffer_load_dword a3, v36, s[12:15], s53 offen
  buffer_load_dword a4, v36, s[12:15], s54 offen
  buffer_load_dword a5, v36, s[12:15], s55 offen
  buffer_load_dword a6, v36, s[12:15], s56 offen
  buffer_load_dword a7, v36, s[12:15], s57 offen
  buffer_load_dword a8, v36, s[12:15], s58 offen
  buffer_load_dword a9, v36, s[12:15], s59 offen
  buffer_load_dword a10, v36, s[12:15], s60 offen
  buffer_load_dword a11, v36, s[12:15], s61 offen
  buffer_load_dword a12, v36, s[12:15], s62 offen
  buffer_load_dword a13, v36, s[12:15], s63 offen
  buffer_load_dword a14, v36, s[12:15], s64 offen
  buffer_load_dword a15, v36, s[12:15], s65 offen
  buffer_load_dword a16, v36, s[12:15], s66 offen
  buffer_load_dword a17, v36, s[12:15], s67 offen
  buffer_load_dword a18, v36, s[12:15], s68 offen
  buffer_load_dword a19, v36, s[12:15], s69 offen
  buffer_load_dword a20, v36, s[12:15], s70 offen
  buffer_load_dword a21, v36, s[12:15], s71 offen
  buffer_load_dword a22, v36, s[12:15], s72 offen
  buffer_load_dword a23, v36, s[12:15], s73 offen
  buffer_load_dword a24, v36, s[12:15], s74 offen
  buffer_load_dword a25, v36, s[12:15], s75 offen
  buffer_load_dword a26, v36, s[12:15], s76 offen
  buffer_load_dword a27, v36, s[12:15], s77 offen
  buffer_load_dword a28, v36, s[12:15], s78 offen
  buffer_load_dword a29, v36, s[12:15], s79 offen
  buffer_load_dword a30, v36, s[12:15], s80 offen
  buffer_load_dword a31, v36, s[12:15], s81 offen
  s_add_u32 s12, s12, 0x100000
  s_addc_u32 s13, s13, 0
  s_sub_u32 s14, s14, 0x100000
  buffer_load_dword a32, v36, s[12:15], s50 offen
  buffer_load_dword a33, v36, s[12:15], s51 offen
  buffer_load_dword a34, v36, s[12:15], s52 offen
  buffer_load_dword a35, v36, s[12:15], s53 offen
  buffer_load_dword a36, v36, s[12:15], s54 offen
  buffer_load_dword a37, v36, s[12:15], s55 offen
  buffer_load_dword a38, v36, s[12:15], s56 offen
  buffer_load_dword a39, v36, s[12:15], s57 offen
  buffer_load_dword a40, v36, s[12:15], s58 offen
  buffer_load_dword a41, v36, s[12:15], s59 offen
  buffer_load_dword a42, v36, s[12:15], s60 offen
  buffer_load_dword a43, v36, s[12:15], s61 offen
  buffer_load_dword a44, v36, s[12:15], s62 offen
  buffer_load_dword a45, v36, s[12:15], s63 offen
  buffer_load_dword a46, v36, s[12:15], s64 offen
  buffer_load_dword a47, v36, s[12:15], s65 offen
  buffer_load_dword a48, v36, s[12:15], s66 offen
  buffer_load_dword a49, v36, s[12:15], s67 offen
  buffer_load_dword a50, v36, s[12:15], s68 offen
  buffer_load_dword a51, v36, s[12:15], s69 offen
  buffer_load_dword a52, v36, s[12:15], s70 offen
  buffer_load_dword a53, v36, s[12:15], s71 offen
  buffer_load_dword a54, v36, s[12:15], s72 offen
  buffer_load_dword a55, v36, s[12:15], s73 offen
  buffer_load_dword a56, v36, s[12:15], s74 offen
  buffer_load_dword a57, v36, s[12:15], s75 offen
  buffer_load_dword a58, v36, s[12:15], s76 offen
  buffer_load_dword a59, v36, s[12:15], s77 offen
  buffer_load_dword a60, v36, s[12:15], s78 offen
  buffer_load_dword a61, v36, s[12:15], s79 offen
  buffer_load_dword a62, v36, s[12:15], s80 offen
  buffer_load_dword a63, v36, s[12:15], s81 offen
  s_mov_b32 s14, 0x400000
  s_mov_b64 s[12:13], s[84:85]
  buffer_load_dword a192, v36, s[12:15], s50 offen
  buffer_load_dword a193, v36, s[12:15], s51 offen
  buffer_load_dword a194, v36, s[12:15], s52 offen
  buffer_load_dword a195, v36, s[12:15], s53 offen
  buffer_load_dword a196, v36, s[12:15], s54 offen
  buffer_load_dword a197, v36, s[12:15], s55 offen
  buffer_load_dword a198, v36, s[12:15], s56 offen
  buffer_load_dword a199, v36, s[12:15], s57 offen
  buffer_load_dword a200, v36, s[12:15], s58 offen
  buffer_load_dword a201, v36, s[12:15], s59 offen
  buffer_load_dword a202, v36, s[12:15], s60 offen
  buffer_load_dword a203, v36, s[12:15], s61 offen
  buffer_load_dword a204, v36, s[12:15], s62 offen
  buffer_load_dword a205, v36, s[12:15], s63 offen
  buffer_load_dword a206, v36, s[12:15], s64 offen
  buffer_load_dword a207, v36, s[12:15], s65 offen
  buffer_load_dword a208, v36, s[12:15], s66 offen
  buffer_load_dword a209, v36, s[12:15], s67 offen
  buffer_load_dword a210, v36, s[12:15], s68 offen
  buffer_load_dword a211, v36, s[12:15], s69 offen
  buffer_load_dword a212, v36, s[12:15], s70 offen
  buffer_load_dword a213, v36, s[12:15], s71 offen
  buffer_load_dword a214, v36, s[12:15], s72 offen
  buffer_load_dword a215, v36, s[12:15], s73 offen
  buffer_load_dword a216, v36, s[12:15], s74 offen
  buffer_load_dword a217, v36, s[12:15], s75 offen
  buffer_load_dword a218, v36, s[12:15], s76 offen
  buffer_load_dword a219, v36, s[12:15], s77 offen
  buffer_load_dword a220, v36, s[12:15], s78 offen
  buffer_load_dword a221, v36, s[12:15], s79 offen
  buffer_load_dword a222, v36, s[12:15], s80 offen
  buffer_load_dword a223, v36, s[12:15], s81 offen
  s_add_u32 s12, s12, 0x100000
  s_addc_u32 s13, s13, 0
  s_sub_u32 s14, s14, 0x100000
  buffer_load_dword a224, v36, s[12:15], s50 offen
  buffer_load_dword a225, v36, s[12:15], s51 offen
  buffer_load_dword a226, v36, s[12:15], s52 offen
  buffer_load_dword a227, v36, s[12:15], s53 offen
  buffer_load_dword a228, v36, s[12:15], s54 offen
  buffer_load_dword a229, v36, s[12:15], s55 offen
  buffer_load_dword a230, v36, s[12:15], s56 offen
  buffer_load_dword a231, v36, s[12:15], s57 offen
  buffer_load_dword a232, v36, s[12:15], s58 offen
  buffer_load_dword a233, v36, s[12:15], s59 offen
  buffer_load_dword a234, v36, s[12:15], s60 offen
  buffer_load_dword a235, v36, s[12:15], s61 offen
  buffer_load_dword a236, v36, s[12:15], s62 offen
  buffer_load_dword a237, v36, s[12:15], s63 offen
  buffer_load_dword a238, v36, s[12:15], s64 offen
  buffer_load_dword a239, v36, s[12:15], s65 offen
  buffer_load_dword a240, v36, s[12:15], s66 offen
  buffer_load_dword a241, v36, s[12:15], s67 offen
  buffer_load_dword a242, v36, s[12:15], s68 offen
  buffer_load_dword a243, v36, s[12:15], s69 offen
  buffer_load_dword a244, v36, s[12:15], s70 offen
  buffer_load_dword a245, v36, s[12:15], s71 offen
  buffer_load_dword a246, v36, s[12:15], s72 offen
  buffer_load_dword a247, v36, s[12:15], s73 offen
  buffer_load_dword a248, v36, s[12:15], s74 offen
  buffer_load_dword a249, v36, s[12:15], s75 offen
  buffer_load_dword a250, v36, s[12:15], s76 offen
  buffer_load_dword a251, v36, s[12:15], s77 offen
  buffer_load_dword a252, v36, s[12:15], s78 offen
  buffer_load_dword a253, v36, s[12:15], s79 offen
  buffer_load_dword a254, v36, s[12:15], s80 offen
  buffer_load_dword a255, v36, s[12:15], s81 offen
  s_add_u32 s12, s12, 0x100000
  s_addc_u32 s13, s13, 0
  s_sub_u32 s14, s14, 0x100000
  buffer_load_dword a128, v36, s[12:15], s50 offen
  buffer_load_dword a129, v36, s[12:15], s51 offen
  s_waitcnt vmcnt(60)
  ds_write_b128 v4, v[128:131] offset:16384
  buffer_load_dword a130, v36, s[12:15], s52 offen
  buffer_load_dword a131, v36, s[12:15], s53 offen
  ds_write_b128 v4, v[132:135] offset:17408
  buffer_load_dword a132, v36, s[12:15], s54 offen
  buffer_load_dword a133, v36, s[12:15], s55 offen
  ds_write_b128 v4, v[136:139] offset:18432
  buffer_load_dword a134, v36, s[12:15], s56 offen
  buffer_load_dword a135, v36, s[12:15], s57 offen
  ds_write_b128 v4, v[140:143] offset:19456
  buffer_load_dword a136, v36, s[12:15], s58 offen
  buffer_load_dword a137, v36, s[12:15], s59 offen
  ds_write_b128 v4, v[144:147] offset:20480
  buffer_load_dword a138, v36, s[12:15], s60 offen
  buffer_load_dword a139, v36, s[12:15], s61 offen
  ds_write_b128 v4, v[148:151] offset:21504
  buffer_load_dword a140, v36, s[12:15], s62 offen
  buffer_load_dword a141, v36, s[12:15], s63 offen
  ds_write_b128 v4, v[152:155] offset:22528
  buffer_load_dword a142, v36, s[12:15], s64 offen
  buffer_load_dword a143, v36, s[12:15], s65 offen
  ds_write_b128 v4, v[156:159] offset:23552
  buffer_load_dword a144, v36, s[12:15], s66 offen
  buffer_load_dword a145, v36, s[12:15], s67 offen
  ds_write_b128 v4, v[160:163] offset:24576
  buffer_load_dword a146, v36, s[12:15], s68 offen
  buffer_load_dword a147, v36, s[12:15], s69 offen
  ds_write_b128 v4, v[164:167] offset:25600
  buffer_load_dword a148, v36, s[12:15], s70 offen
  buffer_load_dword a149, v36, s[12:15], s71 offen
  ds_write_b128 v4, v[168:171] offset:26624
  buffer_load_dword a150, v36, s[12:15], s72 offen
  buffer_load_dword a151, v36, s[12:15], s73 offen
  ds_write_b128 v4, v[172:175] offset:27648
  buffer_load_dword a152, v36, s[12:15], s74 offen
  buffer_load_dword a153, v36, s[12:15], s75 offen
  ds_write_b128 v4, v[176:179] offset:28672
  buffer_load_dword a154, v36, s[12:15], s76 offen
  buffer_load_dword a155, v36, s[12:15], s77 offen
  ds_write_b128 v4, v[180:183] offset:29696
  buffer_load_dword a156, v36, s[12:15], s78 offen
  buffer_load_dword a157, v36, s[12:15], s79 offen
  ds_write_b128 v4, v[184:187] offset:30720
  buffer_load_dword a158, v36, s[12:15], s80 offen
  buffer_load_dword a159, v36, s[12:15], s81 offen
  ds_write_b128 v4, v[188:191] offset:31744
  s_add_u32 s12, s12, 0x100000
  s_addc_u32 s13, s13, 0
  s_sub_u32 s14, s14, 0x100000
  buffer_load_dword a160, v36, s[12:15], s50 offen
  buffer_load_dword a161, v36, s[12:15], s51 offen
  ds_write_b128 v4, v[192:195] offset:0
  buffer_load_dword a162, v36, s[12:15], s52 offen
  buffer_load_dword a163, v36, s[12:15], s53 offen
  ds_write_b128 v4, v[196:199] offset:1024
  buffer_load_dword a164, v36, s[12:15], s54 offen
  buffer_load_dword a165, v36, s[12:15], s55 offen
  ds_write_b128 v4, v[200:203] offset:2048
  buffer_load_dword a166, v36, s[12:15], s56 offen
  buffer_load_dword a167, v36, s[12:15], s57 offen
  ds_write_b128 v4, v[204:207] offset:3072
  buffer_load_dword a168, v36, s[12:15], s58 offen
  buffer_load_dword a169, v36, s[12:15], s59 offen
  ds_write_b128 v4, v[208:211] offset:4096
  buffer_load_dword a170, v36, s[12:15], s60 offen
  buffer_load_dword a171, v36, s[12:15], s61 offen
  ds_write_b128 v4, v[212:215] offset:5120
  buffer_load_dword a172, v36, s[12:15], s62 offen
  buffer_load_dword a173, v36, s[12:15], s63 offen
  ds_write_b128 v4, v[216:219] offset:6144
  buffer_load_dword a174, v36, s[12:15], s64 offen
  buffer_load_dword a175, v36, s[12:15], s65 offen
  ds_write_b128 v4, v[220:223] offset:7168
  buffer_load_dword a176, v36, s[12:15], s66 offen
  buffer_load_dword a177, v36, s[12:15], s67 offen
  ds_write_b128 v4, v[224:227] offset:8192
  buffer_load_dword a178, v36, s[12:15], s68 offen
  buffer_load_dword a179, v36, s[12:15], s69 offen
  ds_write_b128 v4, v[228:231] offset:9216
  buffer_load_dword a180, v36, s[12:15], s70 offen
  buffer_load_dword a181, v36, s[12:15], s71 offen
  ds_write_b128 v4, v[232:235] offset:10240
  buffer_load_dword a182, v36, s[12:15], s72 offen
  buffer_load_dword a183, v36, s[12:15], s73 offen
  ds_write_b128 v4, v[236:239] offset:11264
  buffer_load_dword a184, v36, s[12:15], s74 offen
  buffer_load_dword a185, v36, s[12:15], s75 offen
  ds_write_b128 v4, v[240:243] offset:12288
  buffer_load_dword a186, v36, s[12:15], s76 offen
  buffer_load_dword a187, v36, s[12:15], s77 offen
  ds_write_b128 v4, v[244:247] offset:13312
  buffer_load_dword a188, v36, s[12:15], s78 offen
  buffer_load_dword a189, v36, s[12:15], s79 offen
  ds_write_b128 v4, v[248:251] offset:14336
  buffer_load_dword a190, v36, s[12:15], s80 offen
  buffer_load_dword a191, v36, s[12:15], s81 offen
  ds_write_b128 v4, v[252:255] offset:15360
  s_mov_b32 s14, 0x400000
  s_waitcnt lgkmcnt(0)
  v_mov_b32 v104, 4
  v_mov_b32 v105, 589824
  global_load_dword v106, v104, s[10:11] sc1
  global_load_dword v107, v105, s[8:9] sc1
  s_mov_b64 s[12:13], s[86:87]
  buffer_load_dword v192, v36, s[12:15], s50 offen
  buffer_load_dword v193, v36, s[12:15], s51 offen
  buffer_load_dword v194, v36, s[12:15], s52 offen
  buffer_load_dword v195, v36, s[12:15], s53 offen
  buffer_load_dword v196, v36, s[12:15], s54 offen
  buffer_load_dword v197, v36, s[12:15], s55 offen
  buffer_load_dword v198, v36, s[12:15], s56 offen
  buffer_load_dword v199, v36, s[12:15], s57 offen
  buffer_load_dword v200, v36, s[12:15], s58 offen
  buffer_load_dword v201, v36, s[12:15], s59 offen
  buffer_load_dword v202, v36, s[12:15], s60 offen
  buffer_load_dword v203, v36, s[12:15], s61 offen
  buffer_load_dword v204, v36, s[12:15], s62 offen
  buffer_load_dword v205, v36, s[12:15], s63 offen
  buffer_load_dword v206, v36, s[12:15], s64 offen
  buffer_load_dword v207, v36, s[12:15], s65 offen
  buffer_load_dword v208, v36, s[12:15], s66 offen
  buffer_load_dword v209, v36, s[12:15], s67 offen
  buffer_load_dword v210, v36, s[12:15], s68 offen
  buffer_load_dword v211, v36, s[12:15], s69 offen
  buffer_load_dword v212, v36, s[12:15], s70 offen
  buffer_load_dword v213, v36, s[12:15], s71 offen
  buffer_load_dword v214, v36, s[12:15], s72 offen
  buffer_load_dword v215, v36, s[12:15], s73 offen
  buffer_load_dword v216, v36, s[12:15], s74 offen
  buffer_load_dword v217, v36, s[12:15], s75 offen
  buffer_load_dword v218, v36, s[12:15], s76 offen
  buffer_load_dword v219, v36, s[12:15], s77 offen
  buffer_load_dword v220, v36, s[12:15], s78 offen
  buffer_load_dword v221, v36, s[12:15], s79 offen
  buffer_load_dword v222, v36, s[12:15], s80 offen
  buffer_load_dword v223, v36, s[12:15], s81 offen
  s_add_u32 s12, s12, 0x100000
  s_addc_u32 s13, s13, 0
  s_sub_u32 s14, s14, 0x100000
  buffer_load_dword v224, v36, s[12:15], s50 offen
  buffer_load_dword v225, v36, s[12:15], s51 offen
  buffer_load_dword v226, v36, s[12:15], s52 offen
  buffer_load_dword v227, v36, s[12:15], s53 offen
  buffer_load_dword v228, v36, s[12:15], s54 offen
  buffer_load_dword v229, v36, s[12:15], s55 offen
  buffer_load_dword v230, v36, s[12:15], s56 offen
  buffer_load_dword v231, v36, s[12:15], s57 offen
  buffer_load_dword v232, v36, s[12:15], s58 offen
  buffer_load_dword v233, v36, s[12:15], s59 offen
  buffer_load_dword v234, v36, s[12:15], s60 offen
  buffer_load_dword v235, v36, s[12:15], s61 offen
  buffer_load_dword v236, v36, s[12:15], s62 offen
  buffer_load_dword v237, v36, s[12:15], s63 offen
  buffer_load_dword v238, v36, s[12:15], s64 offen
  buffer_load_dword v239, v36, s[12:15], s65 offen
  buffer_load_dword v240, v36, s[12:15], s66 offen
  buffer_load_dword v241, v36, s[12:15], s67 offen
  buffer_load_dword v242, v36, s[12:15], s68 offen
  buffer_load_dword v243, v36, s[12:15], s69 offen
  buffer_load_dword v244, v36, s[12:15], s70 offen
  buffer_load_dword v245, v36, s[12:15], s71 offen
  buffer_load_dword v246, v36, s[12:15], s72 offen
  buffer_load_dword v247, v36, s[12:15], s73 offen
  buffer_load_dword v248, v36, s[12:15], s74 offen
  buffer_load_dword v249, v36, s[12:15], s75 offen
  buffer_load_dword v250, v36, s[12:15], s76 offen
  buffer_load_dword v251, v36, s[12:15], s77 offen
  buffer_load_dword v252, v36, s[12:15], s78 offen
  buffer_load_dword v253, v36, s[12:15], s79 offen
  buffer_load_dword v254, v36, s[12:15], s80 offen
  buffer_load_dword v255, v36, s[12:15], s81 offen
  s_add_u32 s12, s12, 0x100000
  s_addc_u32 s13, s13, 0
  s_sub_u32 s14, s14, 0x100000
  buffer_load_dword v128, v36, s[12:15], s50 offen
  buffer_load_dword v129, v36, s[12:15], s51 offen
  buffer_load_dword v130, v36, s[12:15], s52 offen
  buffer_load_dword v131, v36, s[12:15], s53 offen
  buffer_load_dword v132, v36, s[12:15], s54 offen
  buffer_load_dword v133, v36, s[12:15], s55 offen
  buffer_load_dword v134, v36, s[12:15], s56 offen
  buffer_load_dword v135, v36, s[12:15], s57 offen
  s_waitcnt vmcnt(60)
  v_readfirstlane_b32 s40, v106
  v_readfirstlane_b32 s41, v107
  s_cmp_ge_u32 s40, 32
  s_cselect_b32 s40, s41, 0
  s_cmp_ge_u32 s40, 128
  s_cbranch_scc0 L_c_nok0_2
  s_add_u32 m0, s43, 8192
  s_mov_b32 s42, 1
  global_load_lds_dwordx4 v14, s[20:21] sc1
  global_load_lds_dwordx4 v14, s[20:21] offset:1024 sc1
L_c_nok0_2:
  buffer_load_dword v136, v36, s[12:15], s58 offen
  buffer_load_dword v137, v36, s[12:15], s59 offen
  buffer_load_dword v138, v36, s[12:15], s60 offen
  buffer_load_dword v139, v36, s[12:15], s61 offen
  buffer_load_dword v140, v36, s[12:15], s62 offen
  buffer_load_dword v141, v36, s[12:15], s63 offen
  buffer_load_dword v142, v36, s[12:15], s64 offen
  buffer_load_dword v143, v36, s[12:15], s65 offen
  buffer_load_dword v144, v36, s[12:15], s66 offen
  buffer_load_dword v145, v36, s[12:15], s67 offen
  buffer_load_dword v146, v36, s[12:15], s68 offen
  buffer_load_dword v147, v36, s[12:15], s69 offen
  buffer_load_dword v148, v36, s[12:15], s70 offen
  buffer_load_dword v149, v36, s[12:15], s71 offen
  buffer_load_dword v150, v36, s[12:15], s72 offen
  buffer_load_dword v151, v36, s[12:15], s73 offen
  buffer_load_dword v152, v36, s[12:15], s74 offen
  buffer_load_dword v153, v36, s[12:15], s75 offen
  buffer_load_dword v154, v36, s[12:15], s76 offen
  buffer_load_dword v155, v36, s[12:15], s77 offen
  buffer_load_dword v156, v36, s[12:15], s78 offen
  buffer_load_dword v157, v36, s[12:15], s79 offen
  buffer_load_dword v158, v36, s[12:15], s80 offen
  buffer_load_dword v159, v36, s[12:15], s81 offen
  s_add_u32 s12, s12, 0x100000
  s_addc_u32 s13, s13, 0
  s_sub_u32 s14, s14, 0x100000
  buffer_load_dword v160, v36, s[12:15], s50 offen
  buffer_load_dword v161, v36, s[12:15], s51 offen
  buffer_load_dword v162, v36, s[12:15], s52 offen
  buffer_load_dword v163, v36, s[12:15], s53 offen
  buffer_load_dword v164, v36, s[12:15], s54 offen
  buffer_load_dword v165, v36, s[12:15], s55 offen
  buffer_load_dword v166, v36, s[12:15], s56 offen
  buffer_load_dword v167, v36, s[12:15], s57 offen
  buffer_load_dword v168, v36, s[12:15], s58 offen
  buffer_load_dword v169, v36, s[12:15], s59 offen
  buffer_load_dword v170, v36, s[12:15], s60 offen
  buffer_load_dword v171, v36, s[12:15], s61 offen
  buffer_load_dword v172, v36, s[12:15], s62 offen
  buffer_load_dword v173, v36, s[12:15], s63 offen
  buffer_load_dword v174, v36, s[12:15], s64 offen
  buffer_load_dword v175, v36, s[12:15], s65 offen
  buffer_load_dword v176, v36, s[12:15], s66 offen
  buffer_load_dword v177, v36, s[12:15], s67 offen
  buffer_load_dword v178, v36, s[12:15], s68 offen
  buffer_load_dword v179, v36, s[12:15], s69 offen
  buffer_load_dword v180, v36, s[12:15], s70 offen
  buffer_load_dword v181, v36, s[12:15], s71 offen
  buffer_load_dword v182, v36, s[12:15], s72 offen
  buffer_load_dword v183, v36, s[12:15], s73 offen
  buffer_load_dword v184, v36, s[12:15], s74 offen
  buffer_load_dword v185, v36, s[12:15], s75 offen
  buffer_load_dword v186, v36, s[12:15], s76 offen
  buffer_load_dword v187, v36, s[12:15], s77 offen
  buffer_load_dword v188, v36, s[12:15], s78 offen
  buffer_load_dword v189, v36, s[12:15], s79 offen
  buffer_load_dword v190, v36, s[12:15], s80 offen
  buffer_load_dword v191, v36, s[12:15], s81 offen
  s_mov_b32 s14, 0x400000
  s_branch L_c_wld
L_c_wl3:
  s_nop 0
  s_mov_b64 s[12:13], s[82:83]
  buffer_load_dword a32, v36, s[12:15], s50 offen
  buffer_load_dword a33, v36, s[12:15], s51 offen
  buffer_load_dword a34, v36, s[12:15], s52 offen
  buffer_load_dword a35, v36, s[12:15], s53 offen
  buffer_load_dword a36, v36, s[12:15], s54 offen
  buffer_load_dword a37, v36, s[12:15], s55 offen
  buffer_load_dword a38, v36, s[12:15], s56 offen
  buffer_load_dword a39, v36, s[12:15], s57 offen
  buffer_load_dword a40, v36, s[12:15], s58 offen
  buffer_load_dword a41, v36, s[12:15], s59 offen
  buffer_load_dword a42, v36, s[12:15], s60 offen
  buffer_load_dword a43, v36, s[12:15], s61 offen
  buffer_load_dword a44, v36, s[12:15], s62 offen
  buffer_load_dword a45, v36, s[12:15], s63 offen
  buffer_load_dword a46, v36, s[12:15], s64 offen
  buffer_load_dword a47, v36, s[12:15], s65 offen
  buffer_load_dword a48, v36, s[12:15], s66 offen
  buffer_load_dword a49, v36, s[12:15], s67 offen
  buffer_load_dword a50, v36, s[12:15], s68 offen
  buffer_load_dword a51, v36, s[12:15], s69 offen
  buffer_load_dword a52, v36, s[12:15], s70 offen
  buffer_load_dword a53, v36, s[12:15], s71 offen
  buffer_load_dword a54, v36, s[12:15], s72 offen
  buffer_load_dword a55, v36, s[12:15], s73 offen
  buffer_load_dword a56, v36, s[12:15], s74 offen
  buffer_load_dword a57, v36, s[12:15], s75 offen
  buffer_load_dword a58, v36, s[12:15], s76 offen
  buffer_load_dword a59, v36, s[12:15], s77 offen
  buffer_load_dword a60, v36, s[12:15], s78 offen
  buffer_load_dword a61, v36, s[12:15], s79 offen
  buffer_load_dword a62, v36, s[12:15], s80 offen
  buffer_load_dword a63, v36, s[12:15], s81 offen
  s_add_u32 s12, s12, 0x100000
  s_addc_u32 s13, s13, 0
  s_sub_u32 s14, s14, 0x100000
  buffer_load_dword v192, v36, s[12:15], s50 offen
  buffer_load_dword v193, v36, s[12:15], s51 offen
  buffer_load_dword v194, v36, s[12:15], s52 offen
  buffer_load_dword v195, v36, s[12:15], s53 offen
  buffer_load_dword v196, v36, s[12:15], s54 offen
  buffer_load_dword v197, v36, s[12:15], s55 offen
  buffer_load_dword v198, v36, s[12:15], s56 offen
  buffer_load_dword v199, v36, s[12:15], s57 offen
  buffer_load_dword v200, v36, s[12:15], s58 offen
  buffer_load_dword v201, v36, s[12:15], s59 offen
  buffer_load_dword v202, v36, s[12:15], s60 offen
  buffer_load_dword v203, v36, s[12:15], s61 offen
  buffer_load_dword v204, v36, s[12:15], s62 offen
  buffer_load_dword v205, v36, s[12:15], s63 offen
  buffer_load_dword v206, v36, s[12:15], s64 offen
  buffer_load_dword v207, v36, s[12:15], s65 offen
  buffer_load_dword v208, v36, s[12:15], s66 offen
  buffer_load_dword v209, v36, s[12:15], s67 offen
  buffer_load_dword v210, v36, s[12:15], s68 offen
  buffer_load_dword v211, v36, s[12:15], s69 offen
  buffer_load_dword v212, v36, s[12:15], s70 offen
  buffer_load_dword v213, v36, s[12:15], s71 offen
  buffer_load_dword v214, v36, s[12:15], s72 offen
  buffer_load_dword v215, v36, s[12:15], s73 offen
  buffer_load_dword v216, v36, s[12:15], s74 offen
  buffer_load_dword v217, v36, s[12:15], s75 offen
  buffer_load_dword v218, v36, s[12:15], s76 offen
  buffer_load_dword v219, v36, s[12:15], s77 offen
  buffer_load_dword v220, v36, s[12:15], s78 offen
  buffer_load_dword v221, v36, s[12:15], s79 offen
  buffer_load_dword v222, v36, s[12:15], s80 offen
  buffer_load_dword v223, v36, s[12:15], s81 offen
  s_add_u32 s12, s12, 0x100000
  s_addc_u32 s13, s13, 0
  s_sub_u32 s14, s14, 0x100000
  buffer_load_dword v224, v36, s[12:15], s50 offen
  buffer_load_dword v225, v36, s[12:15], s51 offen
  buffer_load_dword v226, v36, s[12:15], s52 offen
  buffer_load_dword v227, v36, s[12:15], s53 offen
  buffer_load_dword v228, v36, s[12:15], s54 offen
  buffer_load_dword v229, v36, s[12:15], s55 offen
  buffer_load_dword v230, v36, s[12:15], s56 offen
  buffer_load_dword v231, v36, s[12:15], s57 offen
  buffer_load_dword v232, v36, s[12:15], s58 offen
  buffer_load_dword v233, v36, s[12:15], s59 offen
  buffer_load_dword v234, v36, s[12:15], s60 offen
  buffer_load_dword v235, v36, s[12:15], s61 offen
  buffer_load_dword v236, v36, s[12:15], s62 offen
  buffer_load_dword v237, v36, s[12:15], s63 offen
  buffer_load_dword v238, v36, s[12:15], s64 offen
  buffer_load_dword v239, v36, s[12:15], s65 offen
  buffer_load_dword v240, v36, s[12:15], s66 offen
  buffer_load_dword v241, v36, s[12:15], s67 offen
  buffer_load_dword v242, v36, s[12:15], s68 offen
  buffer_load_dword v243, v36, s[12:15], s69 offen
  buffer_load_dword v244, v36, s[12:15], s70 offen
  buffer_load_dword v245, v36, s[12:15], s71 offen
  buffer_load_dword v246, v36, s[12:15], s72 offen
  buffer_load_dword v247, v36, s[12:15], s73 offen
  buffer_load_dword v248, v36, s[12:15], s74 offen
  buffer_load_dword v249, v36, s[12:15], s75 offen
  buffer_load_dword v250, v36, s[12:15], s76 offen
  buffer_load_dword v251, v36, s[12:15], s77 offen
  buffer_load_dword v252, v36, s[12:15], s78 offen
  buffer_load_dword v253, v36, s[12:15], s79 offen
  buffer_load_dword v254, v36, s[12:15], s80 offen
  buffer_load_dword v255, v36, s[12:15], s81 offen
  s_add_u32 s12, s12, 0x100000
  s_addc_u32 s13, s13, 0
  s_sub_u32 s14, s14, 0x100000
  buffer_load_dword a0, v36, s[12:15], s50 offen
  buffer_load_dword a1, v36, s[12:15], s51 offen
  buffer_load_dword a2, v36, s[12:15], s52 offen
  buffer_load_dword a3, v36, s[12:15], s53 offen
  buffer_load_dword a4, v36, s[12:15], s54 offen
  buffer_load_dword a5, v36, s[12:15], s55 offen
  buffer_load_dword a6, v36, s[12:15], s56 offen
  buffer_load_dword a7, v36, s[12:15], s57 offen
  buffer_load_dword a8, v36, s[12:15], s58 offen
  buffer_load_dword a9, v36, s[12:15], s59 offen
  buffer_load_dword a10, v36, s[12:15], s60 offen
  buffer_load_dword a11, v36, s[12:15], s61 offen
  buffer_load_dword a12, v36, s[12:15], s62 offen
  buffer_load_dword a13, v36, s[12:15], s63 offen
  buffer_load_dword a14, v36, s[12:15], s64 offen
  buffer_load_dword a15, v36, s[12:15], s65 offen
  buffer_load_dword a16, v36, s[12:15], s66 offen
  buffer_load_dword a17, v36, s[12:15], s67 offen
  buffer_load_dword a18, v36, s[12:15], s68 offen
  buffer_load_dword a19, v36, s[12:15], s69 offen
  buffer_load_dword a20, v36, s[12:15], s70 offen
  buffer_load_dword a21, v36, s[12:15], s71 offen
  buffer_load_dword a22, v36, s[12:15], s72 offen
  buffer_load_dword a23, v36, s[12:15], s73 offen
  buffer_load_dword a24, v36, s[12:15], s74 offen
  buffer_load_dword a25, v36, s[12:15], s75 offen
  buffer_load_dword a26, v36, s[12:15], s76 offen
  buffer_load_dword a27, v36, s[12:15], s77 offen
  buffer_load_dword a28, v36, s[12:15], s78 offen
  buffer_load_dword a29, v36, s[12:15], s79 offen
  buffer_load_dword a30, v36, s[12:15], s80 offen
  buffer_load_dword a31, v36, s[12:15], s81 offen
  s_mov_b32 s14, 0x400000
  s_mov_b64 s[12:13], s[84:85]
  buffer_load_dword a160, v36, s[12:15], s50 offen
  buffer_load_dword a161, v36, s[12:15], s51 offen
  buffer_load_dword a162, v36, s[12:15], s52 offen
  buffer_load_dword a163, v36, s[12:15], s53 offen
  buffer_load_dword a164, v36, s[12:15], s54 offen
  buffer_load_dword a165, v36, s[12:15], s55 offen
  buffer_load_dword a166, v36, s[12:15], s56 offen
  buffer_load_dword a167, v36, s[12:15], s57 offen
  buffer_load_dword a168, v36, s[12:15], s58 offen
  buffer_load_dword a169, v36, s[12:15], s59 offen
  buffer_load_dword a170, v36, s[12:15], s60 offen
  buffer_load_dword a171, v36, s[12:15], s61 offen
  buffer_load_dword a172, v36, s[12:15], s62 offen
  buffer_load_dword a173, v36, s[12:15], s63 offen
  buffer_load_dword a174, v36, s[12:15], s64 offen
  buffer_load_dword a175, v36, s[12:15], s65 offen
  buffer_load_dword a176, v36, s[12:15], s66 offen
  buffer_load_dword a177, v36, s[12:15], s67 offen
  buffer_load_dword a178, v36, s[12:15], s68 offen
  buffer_load_dword a179, v36, s[12:15], s69 offen
  buffer_load_dword a180, v36, s[12:15], s70 offen
  buffer_load_dword a181, v36, s[12:15], s71 offen
  buffer_load_dword a182, v36, s[12:15], s72 offen
  buffer_load_dword a183, v36, s[12:15], s73 offen
  buffer_load_dword a184, v36, s[12:15], s74 offen
  buffer_load_dword a185, v36, s[12:15], s75 offen
  buffer_load_dword a186, v36, s[12:15], s76 offen
  buffer_load_dword a187, v36, s[12:15], s77 offen
  buffer_load_dword a188, v36, s[12:15], s78 offen
  buffer_load_dword a189, v36, s[12:15], s79 offen
  buffer_load_dword a190, v36, s[12:15], s80 offen
  buffer_load_dword a191, v36, s[12:15], s81 offen
  s_add_u32 s12, s12, 0x100000
  s_addc_u32 s13, s13, 0
  s_sub_u32 s14, s14, 0x100000
  buffer_load_dword a192, v36, s[12:15], s50 offen
  buffer_load_dword a193, v36, s[12:15], s51 offen
  buffer_load_dword a194, v36, s[12:15], s52 offen
  buffer_load_dword a195, v36, s[12:15], s53 offen
  buffer_load_dword a196, v36, s[12:15], s54 offen
  buffer_load_dword a197, v36, s[12:15], s55 offen
  buffer_load_dword a198, v36, s[12:15], s56 offen
  buffer_load_dword a199, v36, s[12:15], s57 offen
  buffer_load_dword a200, v36, s[12:15], s58 offen
  buffer_load_dword a201, v36, s[12:15], s59 offen
  buffer_load_dword a202, v36, s[12:15], s60 offen
  buffer_load_dword a203, v36, s[12:15], s61 offen
  buffer_load_dword a204, v36, s[12:15], s62 offen
  buffer_load_dword a205, v36, s[12:15], s63 offen
  buffer_load_dword a206, v36, s[12:15], s64 offen
  buffer_load_dword a207, v36, s[12:15], s65 offen
  buffer_load_dword a208, v36, s[12:15], s66 offen
  buffer_load_dword a209, v36, s[12:15], s67 offen
  buffer_load_dword a210, v36, s[12:15], s68 offen
  buffer_load_dword a211, v36, s[12:15], s69 offen
  buffer_load_dword a212, v36, s[12:15], s70 offen
  buffer_load_dword a213, v36, s[12:15], s71 offen
  buffer_load_dword a214, v36, s[12:15], s72 offen
  buffer_load_dword a215, v36, s[12:15], s73 offen
  buffer_load_dword a216, v36, s[12:15], s74 offen
  buffer_load_dword a217, v36, s[12:15], s75 offen
  buffer_load_dword a218, v36, s[12:15], s76 offen
  buffer_load_dword a219, v36, s[12:15], s77 offen
  buffer_load_dword a220, v36, s[12:15], s78 offen
  buffer_load_dword a221, v36, s[12:15], s79 offen
  buffer_load_dword a222, v36, s[12:15], s80 offen
  buffer_load_dword a223, v36, s[12:15], s81 offen
  s_add_u32 s12, s12, 0x100000
  s_addc_u32 s13, s13, 0
  s_sub_u32 s14, s14, 0x100000
  buffer_load_dword a224, v36, s[12:15], s50 offen
  buffer_load_dword a225, v36, s[12:15], s51 offen
  s_waitcnt vmcnt(60)
  ds_write_b128 v4, v[128:131] offset:16384
  buffer_load_dword a226, v36, s[12:15], s52 offen
  buffer_load_dword a227, v36, s[12:15], s53 offen
  ds_write_b128 v4, v[132:135] offset:17408
  buffer_load_dword a228, v36, s[12:15], s54 offen
  buffer_load_dword a229, v36, s[12:15], s55 offen
  ds_write_b128 v4, v[136:139] offset:18432
  buffer_load_dword a230, v36, s[12:15], s56 offen
  buffer_load_dword a231, v36, s[12:15], s57 offen
  ds_write_b128 v4, v[140:143] offset:19456
  buffer_load_dword a232, v36, s[12:15], s58 offen
  buffer_load_dword a233, v36, s[12:15], s59 offen
  ds_write_b128 v4, v[144:147] offset:20480
  buffer_load_dword a234, v36, s[12:15], s60 offen
  buffer_load_dword a235, v36, s[12:15], s61 offen
  ds_write_b128 v4, v[148:151] offset:21504
  buffer_load_dword a236, v36, s[12:15], s62 offen
  buffer_load_dword a237, v36, s[12:15], s63 offen
  ds_write_b128 v4, v[152:155] offset:22528
  buffer_load_dword a238, v36, s[12:15], s64 offen
  buffer_load_dword a239, v36, s[12:15], s65 offen
  ds_write_b128 v4, v[156:159] offset:23552
  buffer_load_dword a240, v36, s[12:15], s66 offen
  buffer_load_dword a241, v36, s[12:15], s67 offen
  ds_write_b128 v4, v[160:163] offset:24576
  buffer_load_dword a242, v36, s[12:15], s68 offen
  buffer_load_dword a243, v36, s[12:15], s69 offen
  ds_write_b128 v4, v[164:167] offset:25600
  buffer_load_dword a244, v36, s[12:15], s70 offen
  buffer_load_dword a245, v36, s[12:15], s71 offen
  ds_write_b128 v4, v[168:171] offset:26624
  buffer_load_dword a246, v36, s[12:15], s72 offen
  buffer_load_dword a247, v36, s[12:15], s73 offen
  ds_write_b128 v4, v[172:175] offset:27648
  buffer_load_dword a248, v36, s[12:15], s74 offen
  buffer_load_dword a249, v36, s[12:15], s75 offen
  ds_write_b128 v4, v[176:179] offset:28672
  buffer_load_dword a250, v36, s[12:15], s76 offen
  buffer_load_dword a251, v36, s[12:15], s77 offen
  ds_write_b128 v4, v[180:183] offset:29696
  buffer_load_dword a252, v36, s[12:15], s78 offen
  buffer_load_dword a253, v36, s[12:15], s79 offen
  ds_write_b128 v4, v[184:187] offset:30720
  buffer_load_dword a254, v36, s[12:15], s80 offen
  buffer_load_dword a255, v36, s[12:15], s81 offen
  ds_write_b128 v4, v[188:191] offset:31744
  s_add_u32 s12, s12, 0x100000
  s_addc_u32 s13, s13, 0
  s_sub_u32 s14, s14, 0x100000
  buffer_load_dword a128, v36, s[12:15], s50 offen
  buffer_load_dword a129, v36, s[12:15], s51 offen
  ds_write_b128 v4, v[192:195] offset:0
  buffer_load_dword a130, v36, s[12:15], s52 offen
  buffer_load_dword a131, v36, s[12:15], s53 offen
  ds_write_b128 v4, v[196:199] offset:1024
  buffer_load_dword a132, v36, s[12:15], s54 offen
  buffer_load_dword a133, v36, s[12:15], s55 offen
  ds_write_b128 v4, v[200:203] offset:2048
  buffer_load_dword a134, v36, s[12:15], s56 offen
  buffer_load_dword a135, v36, s[12:15], s57 offen
  ds_write_b128 v4, v[204:207] offset:3072
  buffer_load_dword a136, v36, s[12:15], s58 offen
  buffer_load_dword a137, v36, s[12:15], s59 offen
  ds_write_b128 v4, v[208:211] offset:4096
  buffer_load_dword a138, v36, s[12:15], s60 offen
  buffer_load_dword a139, v36, s[12:15], s61 offen
  ds_write_b128 v4, v[212:215] offset:5120
  buffer_load_dword a140, v36, s[12:15], s62 offen
  buffer_load_dword a141, v36, s[12:15], s63 offen
  ds_write_b128 v4, v[216:219] offset:6144
  buffer_load_dword a142, v36, s[12:15], s64 offen
  buffer_load_dword a143, v36, s[12:15], s65 offen
  ds_write_b128 v4, v[220:223] offset:7168
  buffer_load_dword a144, v36, s[12:15], s66 offen
  buffer_load_dword a145, v36, s[12:15], s67 offen
  ds_write_b128 v4, v[224:227] offset:8192
  buffer_load_dword a146, v36, s[12:15], s68 offen
  buffer_load_dword a147, v36, s[12:15], s69 offen
  ds_write_b128 v4, v[228:231] offset:9216
  buffer_load_dword a148, v36, s[12:15], s70 offen
  buffer_load_dword a149, v36, s[12:15], s71 offen
  ds_write_b128 v4, v[232:235] offset:10240
  buffer_load_dword a150, v36, s[12:15], s72 offen
  buffer_load_dword a151, v36, s[12:15], s73 offen
  ds_write_b128 v4, v[236:239] offset:11264
  buffer_load_dword a152, v36, s[12:15], s74 offen
  buffer_load_dword a153, v36, s[12:15], s75 offen
  ds_write_b128 v4, v[240:243] offset:12288
  buffer_load_dword a154, v36, s[12:15], s76 offen
  buffer_load_dword a155, v36, s[12:15], s77 offen
  ds_write_b128 v4, v[244:247] offset:13312
  buffer_load_dword a156, v36, s[12:15], s78 offen
  buffer_load_dword a157, v36, s[12:15], s79 offen
  ds_write_b128 v4, v[248:251] offset:14336
  buffer_load_dword a158, v36, s[12:15], s80 offen
  buffer_load_dword a159, v36, s[12:15], s81 offen
  ds_write_b128 v4, v[252:255] offset:15360
  s_mov_b32 s14, 0x400000
  s_waitcnt lgkmcnt(0)
  v_mov_b32 v104, 4
  v_mov_b32 v105, 589824
  global_load_dword v106, v104, s[10:11] sc1
  global_load_dword v107, v105, s[8:9] sc1
  s_mov_b64 s[12:13], s[86:87]
  buffer_load_dword v160, v36, s[12:15], s50 offen
  buffer_load_dword v161, v36, s[12:15], s51 offen
  buffer_load_dword v162, v36, s[12:15], s52 offen
  buffer_load_dword v163, v36, s[12:15], s53 offen
  buffer_load_dword v164, v36, s[12:15], s54 offen
  buffer_load_dword v165, v36, s[12:15], s55 offen
  buffer_load_dword v166, v36, s[12:15], s56 offen
  buffer_load_dword v167, v36, s[12:15], s57 offen
  buffer_load_dword v168, v36, s[12:15], s58 offen
  buffer_load_dword v169, v36, s[12:15], s59 offen
  buffer_load_dword v170, v36, s[12:15], s60 offen
  buffer_load_dword v171, v36, s[12:15], s61 offen
  buffer_load_dword v172, v36, s[12:15], s62 offen
  buffer_load_dword v173, v36, s[12:15], s63 offen
  buffer_load_dword v174, v36, s[12:15], s64 offen
  buffer_load_dword v175, v36, s[12:15], s65 offen
  buffer_load_dword v176, v36, s[12:15], s66 offen
  buffer_load_dword v177, v36, s[12:15], s67 offen
  buffer_load_dword v178, v36, s[12:15], s68 offen
  buffer_load_dword v179, v36, s[12:15], s69 offen
  buffer_load_dword v180, v36, s[12:15], s70 offen
  buffer_load_dword v181, v36, s[12:15], s71 offen
  buffer_load_dword v182, v36, s[12:15], s72 offen
  buffer_load_dword v183, v36, s[12:15], s73 offen
  buffer_load_dword v184, v36, s[12:15], s74 offen
  buffer_load_dword v185, v36, s[12:15], s75 offen
  buffer_load_dword v186, v36, s[12:15], s76 offen
  buffer_load_dword v187, v36, s[12:15], s77 offen
  buffer_load_dword v188, v36, s[12:15], s78 offen
  buffer_load_dword v189, v36, s[12:15], s79 offen
  buffer_load_dword v190, v36, s[12:15], s80 offen
  buffer_load_dword v191, v36, s[12:15], s81 offen
  s_add_u32 s12, s12, 0x100000
  s_addc_u32 s13, s13, 0
  s_sub_u32 s14, s14, 0x100000
  buffer_load_dword v192, v36, s[12:15], s50 offen
  buffer_load_dword v193, v36, s[12:15], s51 offen
  buffer_load_dword v194, v36, s[12:15], s52 offen
  buffer_load_dword v195, v36, s[12:15], s53 offen
  buffer_load_dword v196, v36, s[12:15], s54 offen
  buffer_load_dword v197, v36, s[12:15], s55 offen
  buffer_load_dword v198, v36, s[12:15], s56 offen
  buffer_load_dword v199, v36, s[12:15], s57 offen
  buffer_load_dword v200, v36, s[12:15], s58 offen
  buffer_load_dword v201, v36, s[12:15], s59 offen
  buffer_load_dword v202, v36, s[12:15], s60 offen
  buffer_load_dword v203, v36, s[12:15], s61 offen
  buffer_load_dword v204, v36, s[12:15], s62 offen
  buffer_load_dword v205, v36, s[12:15], s63 offen
  buffer_load_dword v206, v36, s[12:15], s64 offen
  buffer_load_dword v207, v36, s[12:15], s65 offen
  buffer_load_dword v208, v36, s[12:15], s66 offen
  buffer_load_dword v209, v36, s[12:15], s67 offen
  buffer_load_dword v210, v36, s[12:15], s68 offen
  buffer_load_dword v211, v36, s[12:15], s69 offen
  buffer_load_dword v212, v36, s[12:15], s70 offen
  buffer_load_dword v213, v36, s[12:15], s71 offen
  buffer_load_dword v214, v36, s[12:15], s72 offen
  buffer_load_dword v215, v36, s[12:15], s73 offen
  buffer_load_dword v216, v36, s[12:15], s74 offen
  buffer_load_dword v217, v36, s[12:15], s75 offen
  buffer_load_dword v218, v36, s[12:15], s76 offen
  buffer_load_dword v219, v36, s[12:15], s77 offen
  buffer_load_dword v220, v36, s[12:15], s78 offen
  buffer_load_dword v221, v36, s[12:15], s79 offen
  buffer_load_dword v222, v36, s[12:15], s80 offen
  buffer_load_dword v223, v36, s[12:15], s81 offen
  s_add_u32 s12, s12, 0x100000
  s_addc_u32 s13, s13, 0
  s_sub_u32 s14, s14, 0x100000
  buffer_load_dword v224, v36, s[12:15], s50 offen
  buffer_load_dword v225, v36, s[12:15], s51 offen
  buffer_load_dword v226, v36, s[12:15], s52 offen
  buffer_load_dword v227, v36, s[12:15], s53 offen
  buffer_load_dword v228, v36, s[12:15], s54 offen
  buffer_load_dword v229, v36, s[12:15], s55 offen
  buffer_load_dword v230, v36, s[12:15], s56 offen
  buffer_load_dword v231, v36, s[12:15], s57 offen
  s_waitcnt vmcnt(60)
  v_readfirstlane_b32 s40, v106
  v_readfirstlane_b32 s41, v107
  s_cmp_ge_u32 s40, 32
  s_cselect_b32 s40, s41, 0
  s_cmp_ge_u32 s40, 128
  s_cbranch_scc0 L_c_nok0_3
  s_add_u32 m0, s43, 8192
  s_mov_b32 s42, 1
  global_load_lds_dwordx4 v14, s[20:21] sc1
  global_load_lds_dwordx4 v14, s[20:21] offset:1024 sc1
L_c_nok0_3:
  buffer_load_dword v232, v36, s[12:15], s58 offen
  buffer_load_dword v233, v36, s[12:15], s59 offen
  buffer_load_dword v234, v36, s[12:15], s60 offen
  buffer_load_dword v235, v36, s[12:15], s61 offen
  buffer_load_dword v236, v36, s[12:15], s62 offen
  buffer_load_dword v237, v36, s[12:15], s63 offen
  buffer_load_dword v238, v36, s[12:15], s64 offen
  buffer_load_dword v239, v36, s[12:15], s65 offen
  buffer_load_dword v240, v36, s[12:15], s66 offen
  buffer_load_dword v241, v36, s[12:15], s67 offen
  buffer_load_dword v242, v36, s[12:15], s68 offen
  buffer_load_dword v243, v36, s[12:15], s69 offen
  buffer_load_dword v244, v36, s[12:15], s70 offen
  buffer_load_dword v245, v36, s[12:15], s71 offen
  buffer_load_dword v246, v36, s[12:15], s72 offen
  buffer_load_dword v247, v36, s[12:15], s73 offen
  buffer_load_dword v248, v36, s[12:15], s74 offen
  buffer_load_dword v249, v36, s[12:15], s75 offen
  buffer_load_dword v250, v36, s[12:15], s76 offen
  buffer_load_dword v251, v36, s[12:15], s77 offen
  buffer_load_dword v252, v36, s[12:15], s78 offen
  buffer_load_dword v253, v36, s[12:15], s79 offen
  buffer_load_dword v254, v36, s[12:15], s80 offen
  buffer_load_dword v255, v36, s[12:15], s81 offen
  s_add_u32 s12, s12, 0x100000
  s_addc_u32 s13, s13, 0
  s_sub_u32 s14, s14, 0x100000
  buffer_load_dword v128, v36, s[12:15], s50 offen
  buffer_load_dword v129, v36, s[12:15], s51 offen
  buffer_load_dword v130, v36, s[12:15], s52 offen
  buffer_load_dword v131, v36, s[12:15], s53 offen
  buffer_load_dword v132, v36, s[12:15], s54 offen
  buffer_load_dword v133, v36, s[12:15], s55 offen
  buffer_load_dword v134, v36, s[12:15], s56 offen
  buffer_load_dword v135, v36, s[12:15], s57 offen
  buffer_load_dword v136, v36, s[12:15], s58 offen
  buffer_load_dword v137, v36, s[12:15], s59 offen
  buffer_load_dword v138, v36, s[12:15], s60 offen
  buffer_load_dword v139, v36, s[12:15], s61 offen
  buffer_load_dword v140, v36, s[12:15], s62 offen
  buffer_load_dword v141, v36, s[12:15], s63 offen
  buffer_load_dword v142, v36, s[12:15], s64 offen
  buffer_load_dword v143, v36, s[12:15], s65 offen
  buffer_load_dword v144, v36, s[12:15], s66 offen
  buffer_load_dword v145, v36, s[12:15], s67 offen
  buffer_load_dword v146, v36, s[12:15], s68 offen
  buffer_load_dword v147, v36, s[12:15], s69 offen
  buffer_load_dword v148, v36, s[12:15], s70 offen
  buffer_load_dword v149, v36, s[12:15], s71 offen
  buffer_load_dword v150, v36, s[12:15], s72 offen
  buffer_load_dword v151, v36, s[12:15], s73 offen
  buffer_load_dword v152, v36, s[12:15], s74 offen
  buffer_load_dword v153, v36, s[12:15], s75 offen
  buffer_load_dword v154, v36, s[12:15], s76 offen
  buffer_load_dword v155, v36, s[12:15], s77 offen
  buffer_load_dword v156, v36, s[12:15], s78 offen
  buffer_load_dword v157, v36, s[12:15], s79 offen
  buffer_load_dword v158, v36, s[12:15], s80 offen
  buffer_load_dword v159, v36, s[12:15], s81 offen
  s_mov_b32 s14, 0x400000
L_c_wld:
  v_mov_b32 v2, 0x8888
  v_mov_b32 v64, 0xdddd
  v_cmp_le_u32 vcc, 8, v32
  s_nop 1
  v_cndmask_b32 v2, v2, v64, vcc
  v_and_b32 v64, 7, v32
  v_lshlrev_b32 v64, 4, v64
  v_lshlrev_b32 v65, 7, v33
  v_add_u32 v70, v64, v65
  s_mul_i32 s40, s4, 544
  s_add_u32 s40, s40, 24576
  v_mul_u32_u24 v64, 272, v35
  v_lshlrev_b32 v65, 7, v34
  v_lshlrev_b32 v66, 3, v32
  v_add3_u32 v64, v64, v65, v66
  v_add_u32 v5, s40, v64
  v_bfe_u32 v64, v1, 2, 1
  v_mul_u32_u24 v64, 272, v64
  v_and_b32 v65, 1, v1
  v_lshlrev_b32 v65, 7, v65
  v_bfe_u32 v66, v1, 3, 1
  v_lshl_add_u32 v66, v33, 2, v66
  v_lshlrev_b32 v66, 3, v66
  v_add3_u32 v64, v64, v65, v66
  v_add_u32 v6, 24576, v64
  v_lshlrev_b32 v64, 4, v1
  v_add_u32 v8, 8192, v64
  v_lshrrev_b32 v64, 3, v32
  v_lshl_add_u32 v64, v35, 1, v64
  s_lshl_b32 s40, s4, 3
  v_add_u32 v64, s40, v64
  v_lshlrev_b32 v64, 13, v64
  v_bfe_u32 v65, v32, 2, 1
  v_lshl_add_u32 v65, v34, 1, v65
  v_lshlrev_b32 v65, 11, v65
  v_and_b32 v66, 3, v32
  v_lshlrev_b32 v66, 4, v66
  v_add3_u32 v64, v64, v65, v66
  s_lshl_b32 s40, s5, 6
  v_add_u32 v10, s40, v64
  v_lshlrev_b32 v64, 8, v33
  v_and_b32 v65, 3, v32
  v_lshlrev_b32 v65, 6, v65
  v_lshrrev_b32 v66, 2, v32
  v_lshlrev_b32 v66, 4, v66
  v_add3_u32 v64, v64, v65, v66
  s_lshl_b32 s40, s5, 13
  s_add_u32 s40, s40, s43
  v_add_u32 v12, s40, v64
  s_lshl_b32 s40, s5, 8
  s_and_b32 s41, s4, 1
  s_lshl_b32 s41, s41, 7
  s_add_u32 s40, s40, s41
  s_lshr_b32 s41, s4, 1
  s_lshl_b32 s41, s41, 6
  s_add_u32 s40, s40, s41
  v_lshlrev_b32 v64, 4, v32
  v_lshl_add_u32 v64, v33, 2, v64
  v_add_u32 v13, s40, v64
  v_lshlrev_b32 v64, 7, v32
  v_lshl_add_u32 v64, v33, 4, v64
  v_add_u32 v7, s43, v64
  s_lshl_b32 s40, s4, 9
  v_lshlrev_b32 v64, 3, v1
  v_add_u32 v15, s40, v64
  v_mov_b32 v20, 0x3f803f80
  v_mov_b32 v21, 0x3f803f80
  v_mov_b32 v22, 0x3f803f80
  v_mov_b32 v23, 0x3f803f80
  v_mov_b32 v24, 0
  v_mov_b32 v25, 0
  v_mov_b32 v28, 0
  v_mov_b32 v29, 0
  v_and_b32 v64, 3, v32
  v_mov_b32 v65, 0x3f80
  v_mov_b32 v66, 0x3f800000
  v_mov_b32 v26, 0
  v_mov_b32 v27, 0
  v_cmp_eq_u32 vcc, 0, v64
  s_nop 1
  v_cndmask_b32 v26, v26, v65, vcc
  v_cmp_eq_u32 vcc, 1, v64
  s_nop 1
  v_cndmask_b32 v26, v26, v66, vcc
  v_cmp_eq_u32 vcc, 2, v64
  s_nop 1
  v_cndmask_b32 v27, v27, v65, vcc
  v_cmp_eq_u32 vcc, 3, v64
  s_nop 1
  v_cndmask_b32 v27, v27, v66, vcc
  v_mov_b32 v31, -1
  v_mov_b32 v64, -2
  v_cmp_eq_u32 vcc, 0, v33
  s_nop 1
  v_cndmask_b32 v31, v31, v64, vcc
  s_add_u32 s40, s4, 3
  s_and_b32 s40, s40, 3
  s_lshl_b32 s40, s40, 11
  v_add_u32 v9, s40, v70
  s_add_u32 s40, s4, 2
  s_and_b32 s40, s40, 3
  s_lshl_b32 s40, s40, 11
  v_add_u32 v1, s40, v70
  s_add_u32 s40, s4, 1
  s_and_b32 s40, s40, 3
  s_lshl_b32 s40, s40, 11
  v_add_u32 v0, s40, v70
  s_add_u32 s40, s4, 0
  s_and_b32 s40, s40, 3
  s_lshl_b32 s40, s40, 11
  v_add_u32 v3, s40, v70
  s_add_u32 s16, s8, 0
  s_addc_u32 s17, s9, 0
  s_add_u32 s18, s8, 524288
  s_addc_u32 s19, s9, 0
  s_lshl_b32 s40, s5, 13
  s_add_u32 s22, s8, 17825792
  s_addc_u32 s23, s9, 0
  s_add_u32 s22, s22, s40
  s_addc_u32 s23, s23, 0
  s_lshl_b32 s40, s5, 11
  s_add_u32 s24, s8, 51380224
  s_addc_u32 s25, s9, 0
  s_add_u32 s24, s24, s40
  s_addc_u32 s25, s25, 0
  s_add_u32 s26, s8, 55574528
  s_addc_u32 s27, s9, 0
  s_add_u32 s26, s26, s40
  s_addc_u32 s27, s27, 0
  s_mov_b32 s28, 0
  s_mov_b32 s29, 0
  s_mov_b32 s30, 0
  s_mov_b32 s31, 0
  s_mov_b32 s32, 1040356334
  s_mov_b32 s33, 1040356334
  s_mov_b32 s34, -1
  s_mov_b32 s35, 0
  s_mov_b32 s36, 0
  s_mov_b32 s37, -1
  s_mov_b32 s38, 0x000f000f
  s_mov_b32 s39, 0x000f000f
  s_add_u32 s46, s16, 0x8000
  s_addc_u32 s47, s17, 0
  s_mov_b64 s[92:93], s[18:19]
  s_lshl_b32 s40, s5, 7
  s_add_u32 s40, s40, 598016
  s_sub_u32 s40, s40, s43
  s_add_u32 s86, s8, s40
  s_addc_u32 s87, s9, 0
  s_sub_u32 s40, 589824, s43
  s_add_u32 s84, s8, s40
  s_addc_u32 s85, s9, 0
  v_mov_b32 v52, 0
  v_mov_b32 v53, 0
  v_mov_b32 v54, 0
  v_mov_b32 v55, 0
  v_mov_b32 v56, 0
  v_mov_b32 v57, 0
  v_mov_b32 v58, 0
  v_mov_b32 v59, 0
  v_mov_b32 v60, 0
  v_mov_b32 v61, 0
  v_mov_b32 v62, 0
  v_mov_b32 v63, 0
  s_mov_b32 s44, 0
  s_waitcnt vmcnt(0)
  s_cmp_eq_u32 s42, 1
  s_cbranch_scc1 L_c_k0done
L_c_waitready:
  v_mov_b32 v64, 4
  global_load_dword v65, v64, s[10:11] sc1
  s_waitcnt vmcnt(0)
  v_readfirstlane_b32 s40, v65
  s_nop 0
  s_cmp_ge_u32 s40, 32
  s_cbranch_scc1 L_c_ready
  s_add_u32 s44, s44, 1
  s_cmp_gt_u32 s44, 200000
  s_cbranch_scc1 L_c_done
  s_sleep 4
  s_branch L_c_waitready
L_c_ready:
L_c_waitkv:
  v_mov_b32 v64, 589824
  global_load_dword v65, v64, s[8:9] sc1
  s_waitcnt vmcnt(0)
  v_readfirstlane_b32 s40, v65
  s_nop 0
  s_cmp_ge_u32 s40, 128
  s_cbranch_scc1 L_c_kvok
  s_add_u32 s44, s44, 1
  s_cmp_gt_u32 s44, 200000
  s_cbranch_scc1 L_c_done
  s_sleep 4
  s_branch L_c_waitkv
L_c_kvok:
  s_add_u32 m0, s43, 8192
  s_nop 0
  global_load_lds_dwordx4 v14, s[20:21] sc1
  global_load_lds_dwordx4 v14, s[20:21] offset:1024 sc1
L_c_k0done:
  s_add_u32 s20, s20, 0x40000
  s_addc_u32 s21, s21, 0
  v_mov_b32 v11, 128
  s_mov_b64 s[12:13], s[100:101]
  s_mov_b32 s14, 0x400000
  s_add_u32 s41, s4, 0
  s_and_b32 s41, s41, 3
  s_lshl_b32 s50, s41, 15
  s_add_u32 s41, s4, 1
  s_and_b32 s41, s41, 3
  s_lshl_b32 s51, s41, 15
  s_add_u32 s41, s4, 2
  s_and_b32 s41, s41, 3
  s_lshl_b32 s52, s41, 15
  s_add_u32 s41, s4, 3
  s_and_b32 s41, s41, 3
  s_lshl_b32 s53, s41, 15
  s_add_u32 s41, s51, 128
  buffer_load_dword a96, v37, s[12:15], s41 offen
  s_add_u32 s41, s51, 1152
  buffer_load_dword a97, v37, s[12:15], s41 offen
  s_add_u32 s41, s51, 2176
  buffer_load_dword a98, v37, s[12:15], s41 offen
  s_add_u32 s41, s51, 3200
  buffer_load_dword a99, v37, s[12:15], s41 offen
  s_add_u32 s41, s51, 16512
  buffer_load_dword a100, v37, s[12:15], s41 offen
  s_add_u32 s41, s51, 17536
  buffer_load_dword a101, v37, s[12:15], s41 offen
  s_add_u32 s41, s51, 18560
  buffer_load_dword a102, v37, s[12:15], s41 offen
  s_add_u32 s41, s51, 19584
  buffer_load_dword a103, v37, s[12:15], s41 offen
  s_add_u32 s41, s51, 192
  buffer_load_dword a104, v37, s[12:15], s41 offen
  s_add_u32 s41, s51, 1216
  buffer_load_dword a105, v37, s[12:15], s41 offen
  s_add_u32 s41, s51, 2240
  buffer_load_dword a106, v37, s[12:15], s41 offen
  s_add_u32 s41, s51, 3264
  buffer_load_dword a107, v37, s[12:15], s41 offen
  s_add_u32 s41, s51, 16576
  buffer_load_dword a108, v37, s[12:15], s41 offen
  s_add_u32 s41, s51, 17600
  buffer_load_dword a109, v37, s[12:15], s41 offen
  s_add_u32 s41, s51, 18624
  buffer_load_dword a110, v37, s[12:15], s41 offen
  s_add_u32 s41, s51, 19648
  buffer_load_dword a111, v37, s[12:15], s41 offen
  s_add_u32 s41, s52, 128
  buffer_load_dword a112, v37, s[12:15], s41 offen
  s_add_u32 s41, s52, 1152
  buffer_load_dword a113, v37, s[12:15], s41 offen
  s_add_u32 s41, s52, 2176
  buffer_load_dword a114, v37, s[12:15], s41 offen
  s_add_u32 s41, s52, 3200
  buffer_load_dword a115, v37, s[12:15], s41 offen
  s_add_u32 s41, s52, 16512
  buffer_load_dword a116, v37, s[12:15], s41 offen
  s_add_u32 s41, s52, 17536
  buffer_load_dword a117, v37, s[12:15], s41 offen
  s_add_u32 s41, s52, 18560
  buffer_load_dword a118, v37, s[12:15], s41 offen
  s_add_u32 s41, s52, 19584
  buffer_load_dword a119, v37, s[12:15], s41 offen
  s_add_u32 s41, s52, 192
  buffer_load_dword a120, v37, s[12:15], s41 offen
  s_add_u32 s41, s52, 1216
  buffer_load_dword a121, v37, s[12:15], s41 offen
  s_add_u32 s41, s52, 2240
  buffer_load_dword a122, v37, s[12:15], s41 offen
  s_add_u32 s41, s52, 3264
  buffer_load_dword a123, v37, s[12:15], s41 offen
  s_add_u32 s41, s52, 16576
  buffer_load_dword a124, v37, s[12:15], s41 offen
  s_add_u32 s41, s52, 17600
  buffer_load_dword a125, v37, s[12:15], s41 offen
  s_add_u32 s41, s52, 18624
  buffer_load_dword a126, v37, s[12:15], s41 offen
  s_add_u32 s41, s52, 19648
  buffer_load_dword a127, v37, s[12:15], s41 offen
  s_waitcnt vmcnt(32) lgkmcnt(0)
  s_barrier
  ds_read_b128 v[96:99], v3 offset:0
  ds_read_b128 v[100:103], v3 offset:512
  ds_read_b128 v[104:107], v3 offset:1024
  ds_read_b128 v[108:111], v3 offset:1536
  s_waitcnt lgkmcnt(0)
  ds_read_b128 v[120:123], v4 offset:0
  ds_read_b128 v[124:127], v4 offset:1024
  ds_read_b128 v[24:27], v4 offset:2048
  ds_read_b128 v[28:31], v4 offset:3072
  ds_read_b128 v[112:115], v4 offset:4096
  ds_read_b128 v[116:119], v4 offset:5120
  s_waitcnt lgkmcnt(0)
  s_branch L_c_step
L_c_hops:
  v_mov_b64 v[52:53], 0
  v_mov_b64 v[54:55], 0
  v_mov_b64 v[56:57], 0
  v_mov_b64 v[58:59], 0
  v_mov_b64 v[60:61], 0
  v_mov_b64 v[62:63], 0
  v_mov_b64 v[24:25], 0
  v_mov_b64 v[26:27], 0
  v_mov_b64 v[28:29], 0
  s_mov_b32 exec_lo, 0x11111111
  s_mov_b32 exec_hi, 0x11111111
  v_mov_b32 v26, 0x3f80
  s_mov_b32 exec_lo, 0x22222222
  s_mov_b32 exec_hi, 0x22222222
  v_mov_b32 v26, 0x3f800000
  s_mov_b32 exec_lo, 0x44444444
  s_mov_b32 exec_hi, 0x44444444
  v_mov_b32 v27, 0x3f80
  s_mov_b32 exec_lo, 0x88888888
  s_mov_b32 exec_hi, 0x88888888
  v_mov_b32 v27, 0x3f800000
  s_mov_b64 exec, -1
  s_mov_b32 m0, s43
  v_mov_b32 v34, v35
  v_mov_b32 v34, v35
  v_mov_b32 v34, v35
  v_mov_b32 v34, v35
  v_mov_b32 v34, v35
  v_mov_b32 v34, v35
  v_mov_b32 v34, v35
  v_mov_b32 v34, v35
  v_mov_b32 v34, v35
  v_mov_b32 v34, v35
  v_mov_b32 v34, v35
  v_mov_b32 v34, v35
  v_mov_b32 v34, v35
  v_mov_b32 v34, v35
  v_mov_b32 v34, v35
  v_mov_b32 v34, v35
  v_mov_b32 v34, v35
  v_mov_b32 v34, v35
  v_mov_b32 v34, v35
  v_mov_b32 v34, v35
  v_mov_b32 v34, v35
  v_mov_b32 v34, v35
  v_mov_b32 v34, v35
  v_mov_b32 v34, v35
  v_mov_b32 v34, v35
  v_mov_b32 v34, v35
  v_mov_b32 v34, v35
  v_mov_b32 v34, v35
  v_mov_b32 v34, v35
  v_mov_b32 v34, v35
  v_mov_b32 v34, v35
  v_mov_b32 v34, v35
  v_mov_b32 v34, v35
  v_mov_b32 v34, v35
  v_mov_b32 v34, v35
  v_mov_b32 v34, v35
  v_mov_b32 v34, v35
  v_mov_b32 v34, v35
  v_mov_b32 v34, v35
  global_load_dwordx4 v[36:39], v12, s[16:17] sc1
  global_load_dwordx4 v[40:43], v12, s[16:17] offset:1024 sc1
  v_mov_b32 v34, v35
  v_mov_b32 v34, v35
  v_mov_b32 v34, v35
  v_mov_b32 v34, v35
  v_mov_b32 v34, v35
  v_mov_b32 v34, v35
  v_mov_b32 v34, v35
  v_mov_b32 v34, v35
  v_mov_b32 v34, v35
  v_mov_b32 v34, v35
  v_mov_b32 v34, v35
  v_mov_b32 v34, v35
  v_mov_b32 v34, v35
  v_mov_b32 v34, v35
  v_mov_b32 v34, v35
  v_mov_b32 v34, v35
  v_mov_b32 v34, v35
  v_mov_b32 v34, v35
  v_mov_b32 v34, v35
  v_mov_b32 v34, v35
  v_mov_b32 v34, v35
  v_mov_b32 v34, v35
  v_mov_b32 v34, v35
  v_mov_b32 v34, v35
  v_mov_b32 v34, v35
  v_mov_b32 v34, v35
  v_mov_b32 v34, v35
  v_mov_b32 v34, v35
  v_mov_b32 v34, v35
  v_mov_b32 v34, v35
  v_mov_b32 v34, v35
  v_mov_b32 v34, v35
  v_mov_b32 v34, v35
  v_mov_b32 v34, v35
  v_mov_b32 v34, v35
  v_mov_b32 v34, v35
  v_mov_b32 v34, v35
  v_mov_b32 v34, v35
  v_mov_b32 v34, v35
  v_mov_b32 v34, v35
  v_mov_b32 v34, v35
  v_mov_b32 v34, v35
  v_mov_b32 v34, v35
  v_mov_b32 v34, v35
  v_mov_b32 v34, v35
  v_mov_b32 v34, v35
  v_mov_b32 v34, v35
  v_mov_b32 v34, v35
  v_mov_b32 v34, v35
  v_mov_b32 v34, v35
  global_load_dwordx4 v[64:67], v12, s[16:17] sc1
  global_load_dwordx4 v[68:71], v12, s[16:17] offset:1024 sc1
  s_waitcnt vmcnt(3)
  v_mfma_f32_16x16x32_bf16 v[44:47], v[36:39], v[26:29], 0
  v_mfma_f32_16x16x32_bf16 v[48:51], v[36:39], v[24:27], 0
  v_xor_b32 v80, s29, v36
  s_waitcnt vmcnt(2)
  v_mfma_f32_16x16x32_bf16 v[44:47], v[40:43], v[26:29], v[44:47]
  v_mfma_f32_16x16x32_bf16 v[48:51], v[40:43], v[24:27], v[48:51]
  v_bitop3_b32 v80, v80, v40, s29 bitop3:0xf6
  v_and_b32 v80, 1, v80
  v_cmp_ne_u32 vcc, 0, v80
  s_cbranch_vccnz L_c_failA
L_c_okA:
  s_nop 3
  v_pk_add_f32 v[44:45], v[44:45], v[46:47]
  v_pk_add_f32 v[48:49], v[48:49], v[50:51]
  v_add_f32 v44, v44, v45
  v_add_f32 v48, v48, v49
  v_cvt_pk_bf16_f32 v44, v44, v48
  v_and_or_b32 v44, v44, -2, s29
  s_mov_b64 exec, s[38:39]
  global_store_dword v13, v44, s[18:19]
  s_mov_b64 exec, -1
  ds_read_b128 v[120:123], v4 offset:0
  ds_read_b128 v[124:127], v4 offset:1024
  ds_read_b128 v[24:27], v4 offset:2048
  ds_read_b128 v[28:31], v4 offset:3072
  ds_read_b128 v[112:115], v4 offset:4096
  ds_read_b128 v[116:119], v4 offset:5120
  s_mov_b64 s[92:93], s[18:19]
  s_mov_b32 s30, s29
  s_mov_b32 s31, 1
  s_add_u32 s28, s28, 1
  s_and_b32 s40, s28, 1
  s_lshl_b32 s41, s40, 18
  s_add_u32 s16, s8, s41
  s_addc_u32 s17, s9, 0
  s_add_u32 s46, s16, 0x8000
  s_addc_u32 s47, s17, 0
  s_lshl_b32 s41, s40, 13
  s_add_u32 s41, s41, 524288
  s_add_u32 s18, s8, s41
  s_addc_u32 s19, s9, 0
  s_lshr_b32 s29, s28, 1
  s_and_b32 s29, s29, 1
  s_add_u32 s24, s24, 0x10000
  s_addc_u32 s25, s25, 0
  s_add_u32 s26, s26, 0x10000
  s_addc_u32 s27, s27, 0
  v_xor_b32 v8, 0x6000, v8
  v_mov_b32 v34, v35
  v_mov_b32 v34, v35
  v_mov_b32 v34, v35
  v_mov_b32 v34, v35
  v_mov_b32 v34, v35
  v_mov_b32 v34, v35
  v_mov_b32 v34, v35
  v_mov_b32 v34, v35
  v_mov_b32 v34, v35
  v_mov_b32 v34, v35
  v_mov_b32 v34, v35
  v_mov_b32 v34, v35
  v_mov_b32 v34, v35
  v_mov_b32 v34, v35
  v_mov_b32 v34, v35
  v_mov_b32 v34, v35
  v_mov_b32 v34, v35
  v_mov_b32 v34, v35
  v_mov_b32 v34, v35
  v_mov_b32 v34, v35
  v_mov_b32 v34, v35
  v_mov_b32 v34, v35
  v_mov_b32 v34, v35
  v_mov_b32 v34, v35
  v_mov_b32 v34, v35
  v_mov_b32 v34, v35
  v_mov_b32 v34, v35
  v_mov_b32 v34, v35
  v_mov_b32 v34, v35
  v_mov_b32 v34, v35
  v_mov_b32 v34, v35
  v_mov_b32 v34, v35
  v_mov_b32 v34, v35
  v_mov_b32 v34, v35
  v_mov_b32 v34, v35
  v_mov_b32 v34, v35
  v_mov_b32 v34, v35
  v_mov_b32 v34, v35
  v_mov_b32 v34, v35
  v_mov_b32 v34, v35
  global_load_lds_dwordx4 v14, s[92:93] sc1
  global_load_lds_dwordx4 v14, s[92:93] offset:1024 sc1
  v_mov_b32 v34, v35
  v_mov_b32 v34, v35
  v_mov_b32 v34, v35
  v_mov_b32 v34, v35
  v_mov_b32 v34, v35
  v_mov_b32 v34, v35
  v_mov_b32 v34, v35
  v_mov_b32 v34, v35
  v_mov_b32 v34, v35
  v_mov_b32 v34, v35
  v_mov_b32 v34, v35
  v_mov_b32 v34, v35
  v_mov_b32 v34, v35
  v_mov_b32 v34, v35
  v_mov_b32 v34, v35
  v_mov_b32 v34, v35
  v_mov_b32 v34, v35
  v_mov_b32 v34, v35
  v_mov_b32 v34, v35
  v_mov_b32 v34, v35
  v_mov_b32 v34, v35
  v_mov_b32 v34, v35
  v_mov_b32 v34, v35
  v_mov_b32 v34, v35
  v_mov_b32 v34, v35
  v_mov_b32 v34, v35
  v_mov_b32 v34, v35
  v_mov_b32 v34, v35
  v_mov_b32 v34, v35
  v_mov_b32 v34, v35
  global_load_lds_dwordx4 v14, s[92:93] sc1
  global_load_lds_dwordx4 v14, s[92:93] offset:1024 sc1
L_c_loopB:
  s_waitcnt vmcnt(2)
  ds_read_b128 v[96:99], v3 offset:0
  ds_read_b128 v[100:103], v3 offset:512
  ds_read_b128 v[104:107], v3 offset:1024
  ds_read_b128 v[108:111], v3 offset:1536
  s_waitcnt lgkmcnt(3)
  v_xor_b32 v32, s30, v99
  s_waitcnt lgkmcnt(2)
  v_bitop3_b32 v32, v32, v103, s30 bitop3:0xf6
  s_waitcnt lgkmcnt(1)
  v_bitop3_b32 v32, v32, v107, s30 bitop3:0xf6
  s_waitcnt lgkmcnt(0)
  v_bitop3_b32 v32, v32, v111, s30 bitop3:0xf6
  v_and_b32 v32, 1, v32
  v_cmp_ne_u32 vcc, 0, v32
  s_cbranch_vccnz L_c_failB
  s_nop 3
L_c_step:
  v_smfmac_f32_16x16x64_bf16 v[52:55], v[96:99], a[0:7], v2
  s_barrier
  ds_read_b128 v[64:67], v0 offset:0
  ds_read_b128 v[68:71], v0 offset:512
  ds_read_b128 v[72:75], v0 offset:1024
  ds_read_b128 v[76:79], v0 offset:1536
  v_smfmac_f32_16x16x64_bf16 v[56:59], v[96:99], a[128:135], v2
  v_smfmac_f32_16x16x64_bf16 v[52:55], v[100:103], a[8:15], v2
  v_smfmac_f32_16x16x64_bf16 v[56:59], v[100:103], a[136:143], v2
  v_readfirstlane_b32 s40, v11
  v_smfmac_f32_16x16x64_bf16 v[52:55], v[104:107], a[16:23], v2
  ds_read_b128 v[80:83], v1 offset:0
  ds_read_b128 v[84:87], v1 offset:512
  v_smfmac_f32_16x16x64_bf16 v[56:59], v[104:107], a[144:151], v2
  s_and_b32 s41, s28, 1
  s_lshl_b32 s41, s41, 13
  s_sub_u32 s41, 16384, s41
  s_add_u32 m0, s43, s41
  s_cmp_ge_u32 s40, 128
  s_cbranch_scc0 L_c_kvspin
L_c_kvgo:
  v_smfmac_f32_16x16x64_bf16 v[52:55], v[108:111], a[24:31], v2
  ds_read_b128 v[88:91], v1 offset:1024
  ds_read_b128 v[92:95], v1 offset:1536
  v_smfmac_f32_16x16x64_bf16 v[56:59], v[108:111], a[152:159], v2
  s_waitcnt lgkmcnt(7)
  v_smfmac_f32_16x16x64_bf16 v[52:55], v[64:67], a[32:39], v2
  ds_read_b128 v[36:39], v9 offset:0
  ds_read_b128 v[40:43], v9 offset:512
  v_smfmac_f32_16x16x64_bf16 v[56:59], v[64:67], a[160:167], v2
  s_waitcnt lgkmcnt(8)
  v_smfmac_f32_16x16x64_bf16 v[52:55], v[68:71], a[40:47], v2
  ds_read_b128 v[44:47], v9 offset:1024
  ds_read_b128 v[48:51], v9 offset:1536
  v_smfmac_f32_16x16x64_bf16 v[56:59], v[68:71], a[168:175], v2
  global_load_dwordx4 v[32:35], v7, s[22:23] sc1
  s_waitcnt lgkmcnt(9)
  v_smfmac_f32_16x16x64_bf16 v[52:55], v[72:75], a[48:55], v2
  v_smfmac_f32_16x16x64_bf16 v[56:59], v[72:75], a[176:183], v2
  global_load_dwordx4 v[16:19], v7, s[22:23] offset:64 sc1
  s_waitcnt lgkmcnt(8)
  v_smfmac_f32_16x16x64_bf16 v[52:55], v[76:79], a[56:63], v2
  v_smfmac_f32_16x16x64_bf16 v[56:59], v[76:79], a[184:191], v2
  global_load_lds_dwordx4 v14, s[20:21] sc1
  s_waitcnt lgkmcnt(7)
  v_smfmac_f32_16x16x64_bf16 v[52:55], v[80:83], v[120:127], v2
  ds_read_b128 v[120:123], v4 offset:6144
  ds_read_b128 v[124:127], v4 offset:7168
  v_smfmac_f32_16x16x64_bf16 v[56:59], v[80:83], a[192:199], v2
  global_load_lds_dwordx4 v14, s[20:21] offset:1024 sc1
  s_waitcnt lgkmcnt(8)
  v_smfmac_f32_16x16x64_bf16 v[52:55], v[84:87], v[24:31], v2
  ds_read_b128 v[24:27], v4 offset:8192
  ds_read_b128 v[28:31], v4 offset:9216
  v_smfmac_f32_16x16x64_bf16 v[56:59], v[84:87], a[200:207], v2
  s_add_u32 s20, s20, 0x40000
  s_addc_u32 s21, s21, 0
  s_waitcnt lgkmcnt(9)
  v_smfmac_f32_16x16x64_bf16 v[52:55], v[88:91], v[112:119], v2
  ds_read_b128 v[112:115], v4 offset:10240
  ds_read_b128 v[116:119], v4 offset:11264
  v_smfmac_f32_16x16x64_bf16 v[56:59], v[88:91], a[208:215], v2
  s_add_u32 s22, s22, 0x40000
  s_addc_u32 s23, s23, 0
  s_waitcnt lgkmcnt(10)
  s_waitcnt lgkmcnt(4)
  v_smfmac_f32_16x16x64_bf16 v[52:55], v[92:95], v[120:127], v2
  ds_read_b128 v[120:123], v4 offset:12288
  ds_read_b128 v[124:127], v4 offset:13312
  v_smfmac_f32_16x16x64_bf16 v[56:59], v[92:95], a[216:223], v2
  v_mov_b32 v11, s28
  s_mov_b64 exec, 1
  global_store_dword v14, v11, s[86:87] sc1
  s_add_u32 s41, s28, 2
  s_lshr_b32 s41, s41, 2
  s_min_u32 s41, s41, 15
  s_lshl_b32 s41, s41, 7
  s_add_u32 s82, s84, s41
  s_addc_u32 s83, s85, 0
  global_load_dword v11, v14, s[82:83] sc1
  s_mov_b64 exec, -1
  s_waitcnt lgkmcnt(4)
  v_smfmac_f32_16x16x64_bf16 v[52:55], v[36:39], v[24:31], v2
  ds_read_b128 v[24:27], v4 offset:14336
  ds_read_b128 v[28:31], v4 offset:15360
  v_smfmac_f32_16x16x64_bf16 v[56:59], v[36:39], a[224:231], v2
  s_waitcnt lgkmcnt(4)
  v_smfmac_f32_16x16x64_bf16 v[52:55], v[40:43], v[112:119], v2
  v_smfmac_f32_16x16x64_bf16 v[56:59], v[40:43], a[232:239], v2
  s_waitcnt lgkmcnt(2)
  v_smfmac_f32_16x16x64_bf16 v[52:55], v[44:47], v[120:127], v2
  v_smfmac_f32_16x16x64_bf16 v[56:59], v[44:47], a[240:247], v2
  s_waitcnt lgkmcnt(0)
  v_smfmac_f32_16x16x64_bf16 v[52:55], v[48:51], v[24:31], v2
  v_smfmac_f32_16x16x64_bf16 v[56:59], v[48:51], a[248:255], v2
  global_load_dword v30, v14, s[22:23] sc1
  global_load_dword v31, v14, s[22:23] offset:1024 sc1
  v_smfmac_f32_16x16x64_bf16 v[60:63], v[96:99], v[128:135], v2
  s_nop 0
  v_cvt_pk_bf16_f32 v116, v52, v53
  v_cvt_pk_bf16_f32 v117, v54, v55
  ds_write_b64 v5, v[116:117]
  v_smfmac_f32_16x16x64_bf16 v[60:63], v[100:103], v[136:143], v2
  v_cvt_pk_bf16_f32 v118, v56, v57
  v_cvt_pk_bf16_f32 v119, v58, v59
  ds_write_b64 v5, v[118:119] offset:2176
  v_smfmac_f32_16x16x64_bf16 v[60:63], v[104:107], v[144:151], v2
  global_store_dwordx2 v15, v[118:119], s[24:25] sc1
  v_smfmac_f32_16x16x64_bf16 v[60:63], v[108:111], v[152:159], v2
  ds_read_b128 v[96:99], v8 offset:0
  ds_read_b128 v[100:103], v8 offset:4096
  v_smfmac_f32_16x16x64_bf16 v[60:63], v[64:67], v[160:167], v2
  ds_read_b128 v[104:107], v8 offset:1024
  ds_read_b128 v[108:111], v8 offset:5120
  v_smfmac_f32_16x16x64_bf16 v[60:63], v[68:71], v[168:175], v2
  v_smfmac_f32_16x16x64_bf16 v[60:63], v[72:75], v[176:183], v2
  v_smfmac_f32_16x16x64_bf16 v[60:63], v[76:79], v[184:191], v2
  s_waitcnt lgkmcnt(4)
  s_barrier
  ds_read_b64_tr_b16 v[64:65], v6 offset:0
  ds_read_b64_tr_b16 v[66:67], v6 offset:16
  v_smfmac_f32_16x16x64_bf16 v[60:63], v[80:83], v[192:199], v2
  ds_read_b64_tr_b16 v[68:69], v6 offset:544
  ds_read_b64_tr_b16 v[70:71], v6 offset:560
  v_smfmac_f32_16x16x64_bf16 v[60:63], v[84:87], v[200:207], v2
  ds_read_b64_tr_b16 v[72:73], v6 offset:1088
  ds_read_b64_tr_b16 v[74:75], v6 offset:1104
  v_smfmac_f32_16x16x64_bf16 v[60:63], v[88:91], v[208:215], v2
  ds_read_b64_tr_b16 v[76:77], v6 offset:1632
  ds_read_b64_tr_b16 v[78:79], v6 offset:1648
  v_smfmac_f32_16x16x64_bf16 v[60:63], v[92:95], v[216:223], v2
  ds_read_b64_tr_b16 v[80:81], v6 offset:2176
  ds_read_b64_tr_b16 v[82:83], v6 offset:2192
  v_smfmac_f32_16x16x64_bf16 v[60:63], v[36:39], v[224:231], v2
  ds_read_b64_tr_b16 v[84:85], v6 offset:2720
  ds_read_b64_tr_b16 v[86:87], v6 offset:2736
  ds_read_b128 v[36:39], v8 offset:2048
  v_smfmac_f32_16x16x64_bf16 v[60:63], v[40:43], v[232:239], v2
  ds_read_b64_tr_b16 v[88:89], v6 offset:3264
  ds_read_b64_tr_b16 v[90:91], v6 offset:3280
  ds_read_b128 v[40:43], v8 offset:6144
  v_smfmac_f32_16x16x64_bf16 v[60:63], v[44:47], v[240:247], v2
  ds_read_b64_tr_b16 v[92:93], v6 offset:3808
  ds_read_b64_tr_b16 v[94:95], v6 offset:3824
  ds_read_b128 v[44:47], v8 offset:3072
  v_smfmac_f32_16x16x64_bf16 v[60:63], v[48:51], v[248:255], v2
  ds_read_b128 v[48:51], v8 offset:7168
  s_waitcnt lgkmcnt(15)
  v_mfma_f32_16x16x32_bf16 v[112:115], v[96:99], v[64:67], 0
  v_mfma_f32_16x16x32_bf16 v[116:119], v[100:103], v[64:67], 0
  v_mfma_f32_16x16x32_bf16 v[112:115], v[104:107], v[68:71], v[112:115]
  v_mfma_f32_16x16x32_bf16 v[116:119], v[108:111], v[68:71], v[116:119]
  s_waitcnt lgkmcnt(10)
  v_mfma_f32_16x16x32_bf16 v[120:123], v[80:83], v[64:67], 0
  ds_read_b128 v[96:99], v4 offset:16384
  ds_read_b128 v[100:103], v4 offset:17408
  s_waitcnt lgkmcnt(10)
  v_mfma_f32_16x16x32_bf16 v[120:123], v[84:87], v[68:71], v[120:123]
  ds_read_b128 v[104:107], v4 offset:18432
  ds_read_b128 v[108:111], v4 offset:19456
  s_waitcnt lgkmcnt(9)
  v_mfma_f32_16x16x32_bf16 v[120:123], v[88:91], v[72:75], v[120:123]
  s_waitcnt lgkmcnt(6)
  v_mfma_f32_16x16x32_bf16 v[120:123], v[92:95], v[76:79], v[120:123]
  v_mfma_f32_16x16x32_bf16 v[112:115], v[36:39], v[72:75], v[112:115]
  ds_read_b128 v[80:83], v4 offset:20480
  ds_read_b128 v[84:87], v4 offset:21504
  v_mfma_f32_16x16x32_bf16 v[116:119], v[40:43], v[72:75], v[116:119]
  ds_read_b128 v[88:91], v4 offset:22528
  ds_read_b128 v[92:95], v4 offset:23552
  s_waitcnt lgkmcnt(9)
  v_mfma_f32_16x16x32_bf16 v[112:115], v[44:47], v[76:79], v[112:115]
  v_max3_f32 v53, v120, v121, v122
  s_waitcnt lgkmcnt(8)
  v_mfma_f32_16x16x32_bf16 v[116:119], v[48:51], v[76:79], v[116:119]
  v_max_f32 v53, v53, v123
  s_nop 3
  v_max3_f32 v52, v112, v113, v114
  v_max3_f32 v53, v53, v115, v52
  s_nop 0
  v_max3_f32 v52, v116, v117, v118
  v_max3_f32 v52, v52, v119, v53
  v_mov_b32 v53, v52
  s_nop 1
  v_permlane32_swap_b32 v52, v53
  v_max_f32 v52, v52, v53
  v_mov_b32 v53, v52
  s_nop 1
  v_permlane16_swap_b32 v52, v53
  v_max_f32 v52, v52, v53
  v_mul_f32 v54, s32, v52
  v_pk_fma_f32 v[112:113], v[112:113], s[32:33], v[54:55] op_sel_hi:[1,1,0] neg_lo:[0,0,1] neg_hi:[0,0,1]
  v_pk_fma_f32 v[114:115], v[114:115], s[32:33], v[54:55] op_sel_hi:[1,1,0] neg_lo:[0,0,1] neg_hi:[0,0,1]
  v_pk_fma_f32 v[116:117], v[116:117], s[32:33], v[54:55] op_sel_hi:[1,1,0] neg_lo:[0,0,1] neg_hi:[0,0,1]
  v_pk_fma_f32 v[118:119], v[118:119], s[32:33], v[54:55] op_sel_hi:[1,1,0] neg_lo:[0,0,1] neg_hi:[0,0,1]
  v_exp_f32 v112, v112
  v_exp_f32 v113, v113
  v_exp_f32 v114, v114
  v_exp_f32 v115, v115
  v_exp_f32 v116, v116
  v_exp_f32 v117, v117
  v_exp_f32 v118, v118
  v_exp_f32 v119, v119
  v_pk_fma_f32 v[120:121], v[120:121], s[32:33], v[54:55] op_sel_hi:[1,1,0] neg_lo:[0,0,1] neg_hi:[0,0,1]
  v_pk_fma_f32 v[122:123], v[122:123], s[32:33], v[54:55] op_sel_hi:[1,1,0] neg_lo:[0,0,1] neg_hi:[0,0,1]
  v_cvt_pk_bf16_f32 v56, v112, v113
  v_cvt_pk_bf16_f32 v57, v114, v115
  v_cvt_pk_bf16_f32 v58, v116, v117
  v_cvt_pk_bf16_f32 v59, v118, v119
  s_waitcnt vmcnt(7)
  v_exp_f32 v120, v120
  v_mfma_f32_16x16x32_bf16 v[116:119], v[16:19], v[56:59], 0
  ds_read_b128 v[36:39], v4 offset:24576
  v_exp_f32 v121, v121
  v_mfma_f32_16x16x32_bf16 v[112:115], v[32:35], v[56:59], 0
  ds_read_b128 v[40:43], v4 offset:25600
  v_exp_f32 v122, v122
  v_mfma_f32_16x16x32_bf16 v[16:19], v[20:23], v[56:59], 0
  ds_read_b128 v[44:47], v4 offset:26624
  v_exp_f32 v123, v123
  v_cvt_pk_bf16_f32 v60, v60, v61
  v_cvt_pk_bf16_f32 v54, v120, v121
  v_cvt_pk_bf16_f32 v55, v122, v123
  v_cvt_pk_bf16_f32 v61, v62, v63
  v_cndmask_b32 v52, 0, v54, s[34:35]
  v_cndmask_b32 v53, 0, v55, s[34:35]
  s_nop 1
  v_mfma_f32_16x16x16_bf16 v[16:19], v[20:21], v[52:53], v[16:19]
  v_cndmask_b32 v54, 0, v54, s[36:37]
  v_cndmask_b32 v55, 0, v55, s[36:37]
  v_mfma_f32_16x16x16_bf16 v[112:115], v[60:61], v[52:53], v[112:115]
  ds_read_b128 v[48:51], v4 offset:27648
  v_mfma_f32_16x16x16_bf16 v[116:119], v[60:61], v[54:55], v[116:119]
  global_store_dwordx2 v15, v[60:61], s[26:27] sc1
  v_mov_b64 v[56:57], 0
  v_mov_b64 v[58:59], 0
  s_cmp_eq_u32 s28, 63
  s_cbranch_scc1 L_c_done
  v_mov_b64 v[32:33], 0
  v_mov_b64 v[34:35], 0
  v_mov_b64 v[52:53], 0
  v_mov_b64 v[54:55], 0
  v_rcp_f32 v16, v16
  v_mov_b64 v[60:61], 0
  v_mov_b64 v[62:63], 0
  v_pk_mul_f32 v[112:113], v[112:113], v[16:17] op_sel_hi:[1,0]
  v_pk_mul_f32 v[114:115], v[114:115], v[16:17] op_sel_hi:[1,0]
  v_pk_mul_f32 v[116:117], v[116:117], v[16:17] op_sel_hi:[1,0]
  v_pk_mul_f32 v[118:119], v[118:119], v[16:17] op_sel_hi:[1,0]
  v_cvt_pk_bf16_f32 v120, v112, v116
  v_cvt_pk_bf16_f32 v121, v113, v117
  v_cvt_pk_bf16_f32 v122, v114, v118
  v_cvt_pk_bf16_f32 v123, v115, v119
  ds_write_b128 v3, v[120:123] offset:0
  s_waitcnt lgkmcnt(11)
  v_smfmac_f32_16x16x64_bf16 v[52:55], v[120:123], v[96:103], v2
  s_waitcnt lgkmcnt(9)
  v_smfmac_f32_16x16x64_bf16 v[56:59], v[120:123], v[104:111], v2
  s_waitcnt lgkmcnt(7)
  v_smfmac_f32_16x16x64_bf16 v[60:63], v[120:123], v[80:87], v2
  s_waitcnt lgkmcnt(0)
  s_barrier
  ds_read_b128 v[112:115], v0 offset:0
  ds_read_b128 v[116:119], v1 offset:0
  ds_read_b128 v[124:127], v9 offset:0
  v_smfmac_f32_16x16x64_bf16 v[32:35], v[120:123], v[88:95], v2
  ds_read_b128 v[64:67], v4 offset:28672
  ds_read_b128 v[68:71], v4 offset:29696
  ds_read_b128 v[72:75], v4 offset:30720
  ds_read_b128 v[76:79], v4 offset:31744
  s_waitcnt lgkmcnt(6)
  v_smfmac_f32_16x16x64_bf16 v[52:55], v[112:115], v[36:43], v2
  v_smfmac_f32_16x16x64_bf16 v[56:59], v[112:115], v[44:51], v2
  s_waitcnt lgkmcnt(5)
  v_smfmac_f32_16x16x64_bf16 v[52:55], v[116:119], a[64:71], v2
  v_smfmac_f32_16x16x64_bf16 v[56:59], v[116:119], a[72:79], v2
  s_waitcnt lgkmcnt(4)
  v_smfmac_f32_16x16x64_bf16 v[52:55], v[124:127], a[80:87], v2
  v_smfmac_f32_16x16x64_bf16 v[56:59], v[124:127], a[88:95], v2
  v_smfmac_f32_16x16x64_bf16 v[60:63], v[112:115], a[96:103], v2
  v_cvt_pk_bf16_f32 v96, v52, v53
  v_cvt_pk_bf16_f32 v97, v54, v55
  v_smfmac_f32_16x16x64_bf16 v[32:35], v[112:115], a[104:111], v2
  s_nop 0
  v_cvt_pk_bf16_f32 v98, v56, v57
  v_cvt_pk_bf16_f32 v99, v58, v59
  v_and_or_b32 v96, v96, -2, s29
  global_store_dwordx4 v10, v[96:99], s[16:17]
  v_smfmac_f32_16x16x64_bf16 v[60:63], v[116:119], a[112:119], v2
  v_smfmac_f32_16x16x64_bf16 v[32:35], v[116:119], a[120:127], v2
  s_waitcnt lgkmcnt(2)
  v_smfmac_f32_16x16x64_bf16 v[60:63], v[124:127], v[64:71], v2
  s_waitcnt lgkmcnt(0)
  v_smfmac_f32_16x16x64_bf16 v[32:35], v[124:127], v[72:79], v2
L_c_stub:
  s_nop 4
  v_cvt_pk_bf16_f32 v100, v60, v61
  v_cvt_pk_bf16_f32 v101, v62, v63
  s_nop 0
  v_cvt_pk_bf16_f32 v102, v32, v33
  v_cvt_pk_bf16_f32 v103, v34, v35
  v_and_or_b32 v100, v100, -2, s29
  global_store_dwordx4 v10, v[100:103], s[46:47]
  s_branch L_c_hops
L_c_failA:
  s_nop 3
  s_waitcnt vmcnt(1)
  v_mfma_f32_16x16x32_bf16 v[44:47], v[64:67], v[26:29], 0
  v_mfma_f32_16x16x32_bf16 v[48:51], v[64:67], v[24:27], 0
  v_xor_b32 v80, s29, v64
  s_waitcnt vmcnt(0)
  v_mfma_f32_16x16x32_bf16 v[44:47], v[68:71], v[26:29], v[44:47]
  v_mfma_f32_16x16x32_bf16 v[48:51], v[68:71], v[24:27], v[48:51]
  v_bitop3_b32 v80, v80, v68, s29 bitop3:0xf6
  v_and_b32 v80, 1, v80
  v_cmp_ne_u32 vcc, 0, v80
  s_cbranch_vccz L_c_okA
  s_nop 3
L_c_pollA:
  global_load_dwordx4 v[36:39], v12, s[16:17] sc1
  global_load_dwordx4 v[40:43], v12, s[16:17] offset:1024 sc1
  s_waitcnt vmcnt(1)
  v_mfma_f32_16x16x32_bf16 v[44:47], v[36:39], v[26:29], 0
  v_mfma_f32_16x16x32_bf16 v[48:51], v[36:39], v[24:27], 0
  v_xor_b32 v80, s29, v36
  s_waitcnt vmcnt(0)
  v_mfma_f32_16x16x32_bf16 v[44:47], v[40:43], v[26:29], v[44:47]
  v_mfma_f32_16x16x32_bf16 v[48:51], v[40:43], v[24:27], v[48:51]
  v_bitop3_b32 v80, v80, v40, s29 bitop3:0xf6
  v_and_b32 v80, 1, v80
  v_cmp_ne_u32 vcc, 0, v80
  s_cbranch_vccz L_c_okA
  s_add_u32 s44, s44, 1
  s_cmp_gt_u32 s44, 200000
  s_cbranch_scc1 L_c_done
  s_branch L_c_pollA
L_c_failB:
  global_load_lds_dwordx4 v14, s[92:93] sc1
  global_load_lds_dwordx4 v14, s[92:93] offset:1024 sc1
  s_add_u32 s44, s44, 1
  s_cmp_gt_u32 s44, 200000
  s_cbranch_scc1 L_c_done
  s_branch L_c_loopB
L_c_kvspin:
  s_add_u32 s41, s28, 1
  s_lshr_b32 s41, s41, 2
  s_min_u32 s41, s41, 15
  s_lshl_b32 s41, s41, 7
  s_add_u32 s82, s84, s41
  s_addc_u32 s83, s85, 0
  s_mov_b64 exec, 1
  global_load_dword v11, v14, s[82:83] sc1
  s_mov_b64 exec, -1
  s_waitcnt vmcnt(0)
  v_readfirstlane_b32 s40, v11
  s_add_u32 s44, s44, 1
  s_cmp_gt_u32 s44, 200000
  s_cbranch_scc1 L_c_done
  s_cmp_ge_u32 s40, 128
  s_cbranch_scc0 L_c_kvspin
  s_branch L_c_kvgo
L_c_done:
  s_waitcnt vmcnt(0)
  s_barrier
  s_lshl_b32 s41, s5, 7
  s_add_u32 s41, s41, 598016
  v_mov_b32 v34, s41
  v_mov_b32 v35, 64
  s_mov_b64 exec, 1
  global_store_dword v34, v35, s[8:9] sc1
  s_mov_b64 exec, -1
  s_waitcnt vmcnt(0)
  s_branch L_end
L_worker:
  s_sub_u32 s12, s98, 1
  s_lshl_b32 s12, s12, 5
  s_add_u32 s12, s12, s99
  s_cmp_ge_u32 s12, 220
  s_cbranch_scc1 L_gate
  s_lshr_b32 s5, s12, 1
  s_and_b32 s6, s12, 1
  v_and_b32 v1, 63, v0
  v_and_b32 v2, 31, v1
  v_lshrrev_b32 v3, 5, v1
  s_and_b32 s7, s4, 1
  s_lshr_b32 s12, s4, 1
  s_lshr_b32 s37, s5, 5
  s_load_dwordx2 s[20:21], s[0:1], 24
  s_load_dwordx2 s[22:23], s[0:1], 32
  s_load_dwordx2 s[24:25], s[0:1], 16
  s_load_dwordx2 s[26:27], s[0:1], 64
  s_load_dwordx2 s[14:15], s[0:1], 0
  s_waitcnt lgkmcnt(0)
  s_and_b32 s32, s5, 31
  s_lshl_b32 s32, s32, 8
  s_cmp_eq_u32 s37, 0
  s_cselect_b32 s28, s20, s22
  s_cselect_b32 s29, s21, s23
  s_cmp_eq_u32 s37, 2
  s_cselect_b32 s28, s24, s28
  s_cselect_b32 s29, s25, s29
  s_cmp_eq_u32 s37, 3
  s_cselect_b32 s28, s26, s28
  s_cselect_b32 s29, s27, s29
  s_add_u32 s28, s28, s32
  s_addc_u32 s29, s29, 0
  s_mov_b32 s31, 8192
  s_cmp_eq_u32 s37, 3
  s_cselect_b32 s31, 3584, s31
  v_lshrrev_b32 v5, 3, v1
  s_lshl_b32 s16, s4, 7
  v_add_u32 v5, s16, v5
  v_mul_lo_u32 v5, v5, s31
  v_and_b32 v6, 7, v1
  v_bfe_u32 v7, v1, 4, 1
  v_lshlrev_b32 v7, 2, v7
  v_xor_b32 v6, v6, v7
  v_lshl_add_u32 v8, v6, 4, v5
  s_lshl_b32 s30, s31, 3
  s_lshl_b32 s17, s4, 14
  s_add_u32 s34, s28, 0
  s_addc_u32 s35, s29, 0
  s_add_u32 m0, s17, 0
  s_nop 0
  global_load_lds_dwordx4 v8, s[34:35]
  s_add_u32 s34, s34, s30
  s_addc_u32 s35, s35, 0
  s_add_u32 m0, s17, 1024
  s_nop 0
  global_load_lds_dwordx4 v8, s[34:35]
  s_add_u32 s34, s34, s30
  s_addc_u32 s35, s35, 0
  s_add_u32 m0, s17, 2048
  s_nop 0
  global_load_lds_dwordx4 v8, s[34:35]
  s_add_u32 s34, s34, s30
  s_addc_u32 s35, s35, 0
  s_add_u32 m0, s17, 3072
  s_nop 0
  global_load_lds_dwordx4 v8, s[34:35]
  s_add_u32 s34, s34, s30
  s_addc_u32 s35, s35, 0
  s_add_u32 m0, s17, 4096
  s_nop 0
  global_load_lds_dwordx4 v8, s[34:35]
  s_add_u32 s34, s34, s30
  s_addc_u32 s35, s35, 0
  s_add_u32 m0, s17, 5120
  s_nop 0
  global_load_lds_dwordx4 v8, s[34:35]
  s_add_u32 s34, s34, s30
  s_addc_u32 s35, s35, 0
  s_add_u32 m0, s17, 6144
  s_nop 0
  global_load_lds_dwordx4 v8, s[34:35]
  s_add_u32 s34, s34, s30
  s_addc_u32 s35, s35, 0
  s_add_u32 m0, s17, 7168
  s_nop 0
  global_load_lds_dwordx4 v8, s[34:35]
  s_add_u32 s34, s34, s30
  s_addc_u32 s35, s35, 0
  s_add_u32 m0, s17, 8192
  s_nop 0
  global_load_lds_dwordx4 v8, s[34:35]
  s_add_u32 s34, s34, s30
  s_addc_u32 s35, s35, 0
  s_add_u32 m0, s17, 9216
  s_nop 0
  global_load_lds_dwordx4 v8, s[34:35]
  s_add_u32 s34, s34, s30
  s_addc_u32 s35, s35, 0
  s_add_u32 m0, s17, 10240
  s_nop 0
  global_load_lds_dwordx4 v8, s[34:35]
  s_add_u32 s34, s34, s30
  s_addc_u32 s35, s35, 0
  s_add_u32 m0, s17, 11264
  s_nop 0
  global_load_lds_dwordx4 v8, s[34:35]
  s_add_u32 s34, s34, s30
  s_addc_u32 s35, s35, 0
  s_add_u32 m0, s17, 12288
  s_nop 0
  global_load_lds_dwordx4 v8, s[34:35]
  s_add_u32 s34, s34, s30
  s_addc_u32 s35, s35, 0
  s_add_u32 m0, s17, 13312
  s_nop 0
  global_load_lds_dwordx4 v8, s[34:35]
  s_add_u32 s34, s34, s30
  s_addc_u32 s35, s35, 0
  s_add_u32 m0, s17, 14336
  s_nop 0
  global_load_lds_dwordx4 v8, s[34:35]
  s_add_u32 s34, s34, s30
  s_addc_u32 s35, s35, 0
  s_add_u32 m0, s17, 15360
  s_nop 0
  global_load_lds_dwordx4 v8, s[34:35]
  s_add_u32 s34, s34, s30
  s_addc_u32 s35, s35, 0
  s_add_u32 s34, s28, 128
  s_addc_u32 s35, s29, 0
  s_add_u32 m0, s17, 65536
  s_nop 0
  global_load_lds_dwordx4 v8, s[34:35]
  s_add_u32 s34, s34, s30
  s_addc_u32 s35, s35, 0
  s_add_u32 m0, s17, 66560
  s_nop 0
  global_load_lds_dwordx4 v8, s[34:35]
  s_add_u32 s34, s34, s30
  s_addc_u32 s35, s35, 0
  s_add_u32 m0, s17, 67584
  s_nop 0
  global_load_lds_dwordx4 v8, s[34:35]
  s_add_u32 s34, s34, s30
  s_addc_u32 s35, s35, 0
  s_add_u32 m0, s17, 68608
  s_nop 0
  global_load_lds_dwordx4 v8, s[34:35]
  s_add_u32 s34, s34, s30
  s_addc_u32 s35, s35, 0
  s_add_u32 m0, s17, 69632
  s_nop 0
  global_load_lds_dwordx4 v8, s[34:35]
  s_add_u32 s34, s34, s30
  s_addc_u32 s35, s35, 0
  s_add_u32 m0, s17, 70656
  s_nop 0
  global_load_lds_dwordx4 v8, s[34:35]
  s_add_u32 s34, s34, s30
  s_addc_u32 s35, s35, 0
  s_add_u32 m0, s17, 71680
  s_nop 0
  global_load_lds_dwordx4 v8, s[34:35]
  s_add_u32 s34, s34, s30
  s_addc_u32 s35, s35, 0
  s_add_u32 m0, s17, 72704
  s_nop 0
  global_load_lds_dwordx4 v8, s[34:35]
  s_add_u32 s34, s34, s30
  s_addc_u32 s35, s35, 0
  s_add_u32 m0, s17, 73728
  s_nop 0
  global_load_lds_dwordx4 v8, s[34:35]
  s_add_u32 s34, s34, s30
  s_addc_u32 s35, s35, 0
  s_add_u32 m0, s17, 74752
  s_nop 0
  global_load_lds_dwordx4 v8, s[34:35]
  s_add_u32 s34, s34, s30
  s_addc_u32 s35, s35, 0
  s_add_u32 m0, s17, 75776
  s_nop 0
  global_load_lds_dwordx4 v8, s[34:35]
  s_add_u32 s34, s34, s30
  s_addc_u32 s35, s35, 0
  s_add_u32 m0, s17, 76800
  s_nop 0
  global_load_lds_dwordx4 v8, s[34:35]
  s_add_u32 s34, s34, s30
  s_addc_u32 s35, s35, 0
  s_add_u32 m0, s17, 77824
  s_nop 0
  global_load_lds_dwordx4 v8, s[34:35]
  s_add_u32 s34, s34, s30
  s_addc_u32 s35, s35, 0
  s_add_u32 m0, s17, 78848
  s_nop 0
  global_load_lds_dwordx4 v8, s[34:35]
  s_add_u32 s34, s34, s30
  s_addc_u32 s35, s35, 0
  s_add_u32 m0, s17, 79872
  s_nop 0
  global_load_lds_dwordx4 v8, s[34:35]
  s_add_u32 s34, s34, s30
  s_addc_u32 s35, s35, 0
  s_add_u32 m0, s17, 80896
  s_nop 0
  global_load_lds_dwordx4 v8, s[34:35]
  s_add_u32 s34, s34, s30
  s_addc_u32 s35, s35, 0
  v_lshrrev_b32 v5, 5, v1
  v_bfe_u32 v6, v1, 2, 2
  v_lshl_add_u32 v5, v5, 3, v6
  v_lshlrev_b32 v5, 7, v5
  v_bfe_u32 v6, v1, 4, 1
  v_lshl_add_u32 v5, v6, 5, v5
  v_and_b32 v6, 3, v1
  v_lshl_add_u32 v5, v6, 3, v5
  s_lshl_b32 s33, s7, 16
  v_add_u32 v5, s33, v5
  v_bfe_u32 v6, v1, 3, 1
  v_lshlrev_b32 v6, 6, v6
  v_add_u32 v10, v5, v6
  v_xor_b32 v6, 64, v6
  v_add_u32 v11, v5, v6
  v_bfe_u32 v5, v2, 2, 1
  v_lshlrev_b32 v5, 12, v5
  v_lshl_add_u32 v5, v3, 8, v5
  v_lshrrev_b32 v6, 3, v2
  v_lshlrev_b32 v6, 2, v6
  v_and_b32 v7, 3, v2
  v_add_u32 v6, v6, v7
  v_lshl_add_u32 v12, v6, 4, v5
  v_lshrrev_b32 v5, 4, v2
  v_lshlrev_b32 v5, 12, v5
  v_lshl_add_u32 v5, v3, 8, v5
  v_and_b32 v6, 15, v2
  v_lshl_add_u32 v13, v6, 4, v5
  v_lshlrev_b32 v5, 9, v3
  v_lshl_add_u32 v14, v2, 4, v5
  v_and_b32 v5, 15, v1
  v_lshlrev_b32 v5, 6, v5
  v_lshrrev_b32 v6, 4, v1
  v_lshl_add_u32 v15, v6, 4, v5
  s_cmp_eq_u32 s37, 1
  s_cbranch_scc0 L_p_s1
  v_mov_b32 v12, v15
L_p_s1:
  s_cmp_eq_u32 s37, 2
  s_cbranch_scc0 L_p_s2
  v_mov_b32 v12, v13
L_p_s2:
  s_cmp_eq_u32 s37, 3
  s_cbranch_scc0 L_p_s3
  v_mov_b32 v12, v14
L_p_s3:
  v_lshlrev_b32 v5, 10, v2
  s_lshl_b32 s33, s12, 15
  v_add_u32 v5, s33, v5
  v_and_b32 v6, 15, v2
  v_or_b32 v7, 0, v3
  v_xor_b32 v7, v7, v6
  v_lshl_add_u32 v32, v7, 4, v5
  v_or_b32 v7, 2, v3
  v_xor_b32 v7, v7, v6
  v_lshl_add_u32 v33, v7, 4, v5
  v_or_b32 v7, 4, v3
  v_xor_b32 v7, v7, v6
  v_lshl_add_u32 v34, v7, 4, v5
  v_or_b32 v7, 6, v3
  v_xor_b32 v7, v7, v6
  v_lshl_add_u32 v35, v7, 4, v5
  v_or_b32 v7, 8, v3
  v_xor_b32 v7, v7, v6
  v_lshl_add_u32 v36, v7, 4, v5
  v_or_b32 v7, 10, v3
  v_xor_b32 v7, v7, v6
  v_lshl_add_u32 v37, v7, 4, v5
  v_or_b32 v7, 12, v3
  v_xor_b32 v7, v7, v6
  v_lshl_add_u32 v38, v7, 4, v5
  v_or_b32 v7, 14, v3
  v_xor_b32 v7, v7, v6
  v_lshl_add_u32 v39, v7, 4, v5
  v_lshlrev_b32 v9, 4, v1
  s_lshl_b32 s33, s6, 16
  s_lshl_b32 s32, s4, 14
  s_add_u32 s33, s33, s32
  s_add_u32 s14, s14, s33
  s_addc_u32 s15, s15, 0
  s_lshl_b32 s18, s4, 14
  s_waitcnt vmcnt(0)
  s_barrier
  ds_read_b64_tr_b16 a[0:1], v10 offset:0
  ds_read_b64_tr_b16 a[2:3], v10 offset:512
  ds_read_b64_tr_b16 a[128:129], v11 offset:0
  ds_read_b64_tr_b16 a[130:131], v11 offset:512
  ds_read_b64_tr_b16 a[4:5], v10 offset:2048
  ds_read_b64_tr_b16 a[6:7], v10 offset:2560
  ds_read_b64_tr_b16 a[132:133], v11 offset:2048
  ds_read_b64_tr_b16 a[134:135], v11 offset:2560
  ds_read_b64_tr_b16 a[8:9], v10 offset:4096
  ds_read_b64_tr_b16 a[10:11], v10 offset:4608
  ds_read_b64_tr_b16 a[136:137], v11 offset:4096
  ds_read_b64_tr_b16 a[138:139], v11 offset:4608
  s_waitcnt lgkmcnt(4)
  ds_read_b64_tr_b16 a[12:13], v10 offset:6144
  ds_read_b64_tr_b16 a[14:15], v10 offset:6656
  ds_read_b64_tr_b16 a[140:141], v11 offset:6144
  ds_read_b64_tr_b16 a[142:143], v11 offset:6656
  ds_read_b64_tr_b16 a[16:17], v10 offset:8192
  ds_read_b64_tr_b16 a[18:19], v10 offset:8704
  ds_read_b64_tr_b16 a[144:145], v11 offset:8192
  ds_read_b64_tr_b16 a[146:147], v11 offset:8704
  ds_read_b64_tr_b16 a[20:21], v10 offset:10240
  ds_read_b64_tr_b16 a[22:23], v10 offset:10752
  ds_read_b64_tr_b16 a[148:149], v11 offset:10240
  ds_read_b64_tr_b16 a[150:151], v11 offset:10752
  s_waitcnt lgkmcnt(4)
  ds_read_b64_tr_b16 a[24:25], v10 offset:12288
  ds_read_b64_tr_b16 a[26:27], v10 offset:12800
  ds_read_b64_tr_b16 a[152:153], v11 offset:12288
  ds_read_b64_tr_b16 a[154:155], v11 offset:12800
  ds_read_b64_tr_b16 a[28:29], v10 offset:14336
  ds_read_b64_tr_b16 a[30:31], v10 offset:14848
  ds_read_b64_tr_b16 a[156:157], v11 offset:14336
  ds_read_b64_tr_b16 a[158:159], v11 offset:14848
  ds_read_b64_tr_b16 a[32:33], v10 offset:16384
  ds_read_b64_tr_b16 a[34:35], v10 offset:16896
  ds_read_b64_tr_b16 a[160:161], v11 offset:16384
  ds_read_b64_tr_b16 a[162:163], v11 offset:16896
  s_waitcnt lgkmcnt(4)
  ds_read_b64_tr_b16 a[36:37], v10 offset:18432
  ds_read_b64_tr_b16 a[38:39], v10 offset:18944
  ds_read_b64_tr_b16 a[164:165], v11 offset:18432
  ds_read_b64_tr_b16 a[166:167], v11 offset:18944
  ds_read_b64_tr_b16 a[40:41], v10 offset:20480
  ds_read_b64_tr_b16 a[42:43], v10 offset:20992
  ds_read_b64_tr_b16 a[168:169], v11 offset:20480
  ds_read_b64_tr_b16 a[170:171], v11 offset:20992
  ds_read_b64_tr_b16 a[44:45], v10 offset:22528
  ds_read_b64_tr_b16 a[46:47], v10 offset:23040
  ds_read_b64_tr_b16 a[172:173], v11 offset:22528
  ds_read_b64_tr_b16 a[174:175], v11 offset:23040
  s_waitcnt lgkmcnt(4)
  ds_read_b64_tr_b16 a[48:49], v10 offset:24576
  ds_read_b64_tr_b16 a[50:51], v10 offset:25088
  ds_read_b64_tr_b16 a[176:177], v11 offset:24576
  ds_read_b64_tr_b16 a[178:179], v11 offset:25088
  ds_read_b64_tr_b16 a[52:53], v10 offset:26624
  ds_read_b64_tr_b16 a[54:55], v10 offset:27136
  ds_read_b64_tr_b16 a[180:181], v11 offset:26624
  ds_read_b64_tr_b16 a[182:183], v11 offset:27136
  ds_read_b64_tr_b16 a[56:57], v10 offset:28672
  ds_read_b64_tr_b16 a[58:59], v10 offset:29184
  ds_read_b64_tr_b16 a[184:185], v11 offset:28672
  ds_read_b64_tr_b16 a[186:187], v11 offset:29184
  s_waitcnt lgkmcnt(4)
  ds_read_b64_tr_b16 a[60:61], v10 offset:30720
  ds_read_b64_tr_b16 a[62:63], v10 offset:31232
  ds_read_b64_tr_b16 a[188:189], v11 offset:30720
  ds_read_b64_tr_b16 a[190:191], v11 offset:31232
  ds_read_b64_tr_b16 a[64:65], v10 offset:32768
  ds_read_b64_tr_b16 a[66:67], v10 offset:33280
  ds_read_b64_tr_b16 a[192:193], v11 offset:32768
  ds_read_b64_tr_b16 a[194:195], v11 offset:33280
  ds_read_b64_tr_b16 a[68:69], v10 offset:34816
  ds_read_b64_tr_b16 a[70:71], v10 offset:35328
  ds_read_b64_tr_b16 a[196:197], v11 offset:34816
  ds_read_b64_tr_b16 a[198:199], v11 offset:35328
  s_waitcnt lgkmcnt(4)
  ds_read_b64_tr_b16 a[72:73], v10 offset:36864
  ds_read_b64_tr_b16 a[74:75], v10 offset:37376
  ds_read_b64_tr_b16 a[200:201], v11 offset:36864
  ds_read_b64_tr_b16 a[202:203], v11 offset:37376
  ds_read_b64_tr_b16 a[76:77], v10 offset:38912
  ds_read_b64_tr_b16 a[78:79], v10 offset:39424
  ds_read_b64_tr_b16 a[204:205], v11 offset:38912
  ds_read_b64_tr_b16 a[206:207], v11 offset:39424
  ds_read_b64_tr_b16 a[80:81], v10 offset:40960
  ds_read_b64_tr_b16 a[82:83], v10 offset:41472
  ds_read_b64_tr_b16 a[208:209], v11 offset:40960
  ds_read_b64_tr_b16 a[210:211], v11 offset:41472
  s_waitcnt lgkmcnt(4)
  ds_read_b64_tr_b16 a[84:85], v10 offset:43008
  ds_read_b64_tr_b16 a[86:87], v10 offset:43520
  ds_read_b64_tr_b16 a[212:213], v11 offset:43008
  ds_read_b64_tr_b16 a[214:215], v11 offset:43520
  ds_read_b64_tr_b16 a[88:89], v10 offset:45056
  ds_read_b64_tr_b16 a[90:91], v10 offset:45568
  ds_read_b64_tr_b16 a[216:217], v11 offset:45056
  ds_read_b64_tr_b16 a[218:219], v11 offset:45568
  ds_read_b64_tr_b16 a[92:93], v10 offset:47104
  ds_read_b64_tr_b16 a[94:95], v10 offset:47616
  ds_read_b64_tr_b16 a[220:221], v11 offset:47104
  ds_read_b64_tr_b16 a[222:223], v11 offset:47616
  s_waitcnt lgkmcnt(4)
  ds_read_b64_tr_b16 a[96:97], v10 offset:49152
  ds_read_b64_tr_b16 a[98:99], v10 offset:49664
  ds_read_b64_tr_b16 a[224:225], v11 offset:49152
  ds_read_b64_tr_b16 a[226:227], v11 offset:49664
  ds_read_b64_tr_b16 a[100:101], v10 offset:51200
  ds_read_b64_tr_b16 a[102:103], v10 offset:51712
  ds_read_b64_tr_b16 a[228:229], v11 offset:51200
  ds_read_b64_tr_b16 a[230:231], v11 offset:51712
  ds_read_b64_tr_b16 a[104:105], v10 offset:53248
  ds_read_b64_tr_b16 a[106:107], v10 offset:53760
  ds_read_b64_tr_b16 a[232:233], v11 offset:53248
  ds_read_b64_tr_b16 a[234:235], v11 offset:53760
  s_waitcnt lgkmcnt(4)
  ds_read_b64_tr_b16 a[108:109], v10 offset:55296
  ds_read_b64_tr_b16 a[110:111], v10 offset:55808
  ds_read_b64_tr_b16 a[236:237], v11 offset:55296
  ds_read_b64_tr_b16 a[238:239], v11 offset:55808
  ds_read_b64_tr_b16 a[112:113], v10 offset:57344
  ds_read_b64_tr_b16 a[114:115], v10 offset:57856
  ds_read_b64_tr_b16 a[240:241], v11 offset:57344
  ds_read_b64_tr_b16 a[242:243], v11 offset:57856
  ds_read_b64_tr_b16 a[116:117], v10 offset:59392
  ds_read_b64_tr_b16 a[118:119], v10 offset:59904
  ds_read_b64_tr_b16 a[244:245], v11 offset:59392
  ds_read_b64_tr_b16 a[246:247], v11 offset:59904
  s_waitcnt lgkmcnt(4)
  ds_read_b64_tr_b16 a[120:121], v10 offset:61440
  ds_read_b64_tr_b16 a[122:123], v10 offset:61952
  ds_read_b64_tr_b16 a[248:249], v11 offset:61440
  ds_read_b64_tr_b16 a[250:251], v11 offset:61952
  ds_read_b64_tr_b16 a[124:125], v10 offset:63488
  ds_read_b64_tr_b16 a[126:127], v10 offset:64000
  ds_read_b64_tr_b16 a[252:253], v11 offset:63488
  ds_read_b64_tr_b16 a[254:255], v11 offset:64000
  s_waitcnt lgkmcnt(0)
  s_barrier
  s_mov_b32 s19, 0
  s_mov_b32 s38, 0
  s_mov_b32 s33, s18
  v_xor_b32 v40, 0, v9
  s_add_u32 m0, s33, 0
  s_nop 0
  global_load_lds_dwordx4 v40, s[14:15]
  s_add_u32 s14, s14, 1024
  s_addc_u32 s15, s15, 0
  v_xor_b32 v40, 16, v9
  s_add_u32 m0, s33, 1024
  s_nop 0
  global_load_lds_dwordx4 v40, s[14:15]
  s_add_u32 s14, s14, 1024
  s_addc_u32 s15, s15, 0
  v_xor_b32 v40, 32, v9
  s_add_u32 m0, s33, 2048
  s_nop 0
  global_load_lds_dwordx4 v40, s[14:15]
  s_add_u32 s14, s14, 1024
  s_addc_u32 s15, s15, 0
  v_xor_b32 v40, 48, v9
  s_add_u32 m0, s33, 3072
  s_nop 0
  global_load_lds_dwordx4 v40, s[14:15]
  s_add_u32 s14, s14, 1024
  s_addc_u32 s15, s15, 0
  v_xor_b32 v40, 64, v9
  s_add_u32 m0, s33, 4096
  s_nop 0
  global_load_lds_dwordx4 v40, s[14:15]
  s_add_u32 s14, s14, 1024
  s_addc_u32 s15, s15, 0
  v_xor_b32 v40, 80, v9
  s_add_u32 m0, s33, 5120
  s_nop 0
  global_load_lds_dwordx4 v40, s[14:15]
  s_add_u32 s14, s14, 1024
  s_addc_u32 s15, s15, 0
  v_xor_b32 v40, 96, v9
  s_add_u32 m0, s33, 6144
  s_nop 0
  global_load_lds_dwordx4 v40, s[14:15]
  s_add_u32 s14, s14, 1024
  s_addc_u32 s15, s15, 0
  v_xor_b32 v40, 112, v9
  s_add_u32 m0, s33, 7168
  s_nop 0
  global_load_lds_dwordx4 v40, s[14:15]
  s_add_u32 s14, s14, 1024
  s_addc_u32 s15, s15, 0
  v_xor_b32 v40, 128, v9
  s_add_u32 m0, s33, 8192
  s_nop 0
  global_load_lds_dwordx4 v40, s[14:15]
  s_add_u32 s14, s14, 1024
  s_addc_u32 s15, s15, 0
  v_xor_b32 v40, 144, v9
  s_add_u32 m0, s33, 9216
  s_nop 0
  global_load_lds_dwordx4 v40, s[14:15]
  s_add_u32 s14, s14, 1024
  s_addc_u32 s15, s15, 0
  v_xor_b32 v40, 160, v9
  s_add_u32 m0, s33, 10240
  s_nop 0
  global_load_lds_dwordx4 v40, s[14:15]
  s_add_u32 s14, s14, 1024
  s_addc_u32 s15, s15, 0
  v_xor_b32 v40, 176, v9
  s_add_u32 m0, s33, 11264
  s_nop 0
  global_load_lds_dwordx4 v40, s[14:15]
  s_add_u32 s14, s14, 1024
  s_addc_u32 s15, s15, 0
  v_xor_b32 v40, 192, v9
  s_add_u32 m0, s33, 12288
  s_nop 0
  global_load_lds_dwordx4 v40, s[14:15]
  s_add_u32 s14, s14, 1024
  s_addc_u32 s15, s15, 0
  v_xor_b32 v40, 208, v9
  s_add_u32 m0, s33, 13312
  s_nop 0
  global_load_lds_dwordx4 v40, s[14:15]
  s_add_u32 s14, s14, 1024
  s_addc_u32 s15, s15, 0
  v_xor_b32 v40, 224, v9
  s_add_u32 m0, s33, 14336
  s_nop 0
  global_load_lds_dwordx4 v40, s[14:15]
  s_add_u32 s14, s14, 1024
  s_addc_u32 s15, s15, 0
  v_xor_b32 v40, 240, v9
  s_add_u32 m0, s33, 15360
  s_nop 0
  global_load_lds_dwordx4 v40, s[14:15]
  s_add_u32 s14, s14, 1024
  s_addc_u32 s15, s15, 0
  s_add_u32 s14, s14, 114688
  s_addc_u32 s15, s15, 0
  s_lshl_b32 s39, s6, 1
  s_add_u32 s39, s39, s12
  s_and_b32 s40, s5, 31
  s_cmp_eq_u32 s37, 3
  s_cbranch_scc1 L_p_obH
  s_lshl_b32 s41, s39, 5
  s_add_u32 s41, s41, s40
  s_lshl_b32 s41, s41, 13
  s_mov_b32 s44, 1048576
  s_cmp_eq_u32 s37, 1
  s_cselect_b32 s42, 12, 11
  s_lshl_b32 s42, s7, s42
  s_add_u32 s41, s41, s42
  s_mov_b32 s42, 1048576
  s_cmp_eq_u32 s37, 1
  s_cselect_b32 s42, 17825792, s42
  s_cmp_eq_u32 s37, 2
  s_cselect_b32 s42, 34603008, s42
  s_add_u32 s41, s41, s42
  s_branch L_p_obd
L_p_obH:
  s_mul_i32 s41, s39, 114688
  s_lshl_b32 s42, s40, 1
  s_add_u32 s42, s42, s7
  s_lshl_b32 s42, s42, 12
  s_add_u32 s41, s41, s42
  s_add_u32 s41, s41, 59768832
  s_mov_b32 s44, 458752
L_p_obd:
  s_add_u32 s42, s8, s41
  s_addc_u32 s43, s9, 0
  s_max_u32 s45, s37, 1
  s_sub_u32 s45, s45, 1
  s_lshl_b32 s45, s45, 11
  s_add_u32 s45, s45, 589824
  s_mov_b32 s47, 0
L_p_wr:
  v_mov_b32 v17, 4
  global_load_dword v18, v17, s[10:11] sc1
  s_waitcnt vmcnt(0)
  v_readfirstlane_b32 s46, v18
  s_nop 0
  s_cmp_ge_u32 s46, 32
  s_cbranch_scc1 L_p_wrd
  s_add_u32 s47, s47, 1
  s_cmp_gt_u32 s47, 200000
  s_cbranch_scc1 L_p_wrd
  s_sleep 4
  s_branch L_p_wr
L_p_wrd:
  s_waitcnt vmcnt(0)
L_p_it:
  s_barrier
  s_cmp_lt_u32 s38, 3
  s_cbranch_scc1 L_p_nosig
  s_cmp_eq_u32 s4, 0
  s_cbranch_scc0 L_p_nosig
  s_sub_u32 s47, s38, 2
  s_lshl_b32 s47, s47, 7
  s_add_u32 s47, s47, s45
  v_mov_b32 v17, s47
  v_mov_b32 v18, 1
  s_mov_b64 exec, 1
  global_atomic_add v17, v18, s[8:9] sc1
  s_mov_b64 exec, -1
L_p_nosig:
  s_xor_b32 s36, s19, 0x10000
  s_add_u32 s33, s18, s36
  v_mov_b64 v[64:65], 0
  v_mov_b64 v[66:67], 0
  v_mov_b64 v[68:69], 0
  v_mov_b64 v[70:71], 0
  v_mov_b64 v[72:73], 0
  v_mov_b64 v[74:75], 0
  v_mov_b64 v[76:77], 0
  v_mov_b64 v[78:79], 0
  v_mov_b64 v[80:81], 0
  v_mov_b64 v[82:83], 0
  v_mov_b64 v[84:85], 0
  v_mov_b64 v[86:87], 0
  v_mov_b64 v[88:89], 0
  v_mov_b64 v[90:91], 0
  v_mov_b64 v[92:93], 0
  v_mov_b64 v[94:95], 0
  s_cmp_eq_u32 s37, 1
  s_cbranch_scc1 L_p_kV
  ds_read_b128 v[96:99], v32 offset:0
  ds_read_b128 v[100:103], v33 offset:0
  ds_read_b128 v[104:107], v34 offset:0
  s_waitcnt lgkmcnt(2)
  v_mfma_f32_32x32x16_bf16 v[64:79], a[0:3], v[96:99], v[64:79]
  ds_read_b128 v[108:111], v35 offset:0
  v_mfma_f32_32x32x16_bf16 v[80:95], a[128:131], v[96:99], v[80:95]
  v_xor_b32 v40, 0, v9
  s_add_u32 m0, s33, 0
  s_nop 0
  global_load_lds_dwordx4 v40, s[14:15]
  s_add_u32 s14, s14, 1024
  s_addc_u32 s15, s15, 0
  s_waitcnt lgkmcnt(2)
  v_mfma_f32_32x32x16_bf16 v[64:79], a[4:7], v[100:103], v[64:79]
  ds_read_b128 v[96:99], v36 offset:0
  v_mfma_f32_32x32x16_bf16 v[80:95], a[132:135], v[100:103], v[80:95]
  v_xor_b32 v40, 16, v9
  s_add_u32 m0, s33, 1024
  s_nop 0
  global_load_lds_dwordx4 v40, s[14:15]
  s_add_u32 s14, s14, 1024
  s_addc_u32 s15, s15, 0
  s_waitcnt lgkmcnt(2)
  v_mfma_f32_32x32x16_bf16 v[64:79], a[8:11], v[104:107], v[64:79]
  ds_read_b128 v[100:103], v37 offset:0
  v_mfma_f32_32x32x16_bf16 v[80:95], a[136:139], v[104:107], v[80:95]
  v_xor_b32 v40, 32, v9
  s_add_u32 m0, s33, 2048
  s_nop 0
  global_load_lds_dwordx4 v40, s[14:15]
  s_add_u32 s14, s14, 1024
  s_addc_u32 s15, s15, 0
  s_waitcnt lgkmcnt(2)
  v_mfma_f32_32x32x16_bf16 v[64:79], a[12:15], v[108:111], v[64:79]
  ds_read_b128 v[104:107], v38 offset:0
  v_mfma_f32_32x32x16_bf16 v[80:95], a[140:143], v[108:111], v[80:95]
  v_xor_b32 v40, 48, v9
  s_add_u32 m0, s33, 3072
  s_nop 0
  global_load_lds_dwordx4 v40, s[14:15]
  s_add_u32 s14, s14, 1024
  s_addc_u32 s15, s15, 0
  s_waitcnt lgkmcnt(2)
  v_mfma_f32_32x32x16_bf16 v[64:79], a[16:19], v[96:99], v[64:79]
  ds_read_b128 v[108:111], v39 offset:0
  v_mfma_f32_32x32x16_bf16 v[80:95], a[144:147], v[96:99], v[80:95]
  v_xor_b32 v40, 64, v9
  s_add_u32 m0, s33, 4096
  s_nop 0
  global_load_lds_dwordx4 v40, s[14:15]
  s_add_u32 s14, s14, 1024
  s_addc_u32 s15, s15, 0
  s_waitcnt lgkmcnt(2)
  v_mfma_f32_32x32x16_bf16 v[64:79], a[20:23], v[100:103], v[64:79]
  ds_read_b128 v[96:99], v32 offset:256
  v_mfma_f32_32x32x16_bf16 v[80:95], a[148:151], v[100:103], v[80:95]
  v_xor_b32 v40, 80, v9
  s_add_u32 m0, s33, 5120
  s_nop 0
  global_load_lds_dwordx4 v40, s[14:15]
  s_add_u32 s14, s14, 1024
  s_addc_u32 s15, s15, 0
  s_waitcnt lgkmcnt(2)
  v_mfma_f32_32x32x16_bf16 v[64:79], a[24:27], v[104:107], v[64:79]
  ds_read_b128 v[100:103], v33 offset:256
  v_mfma_f32_32x32x16_bf16 v[80:95], a[152:155], v[104:107], v[80:95]
  v_xor_b32 v40, 96, v9
  s_add_u32 m0, s33, 6144
  s_nop 0
  global_load_lds_dwordx4 v40, s[14:15]
  s_add_u32 s14, s14, 1024
  s_addc_u32 s15, s15, 0
  s_waitcnt lgkmcnt(2)
  v_mfma_f32_32x32x16_bf16 v[64:79], a[28:31], v[108:111], v[64:79]
  ds_read_b128 v[104:107], v34 offset:256
  v_mfma_f32_32x32x16_bf16 v[80:95], a[156:159], v[108:111], v[80:95]
  v_xor_b32 v40, 112, v9
  s_add_u32 m0, s33, 7168
  s_nop 0
  global_load_lds_dwordx4 v40, s[14:15]
  s_add_u32 s14, s14, 1024
  s_addc_u32 s15, s15, 0
  s_waitcnt lgkmcnt(2)
  v_mfma_f32_32x32x16_bf16 v[64:79], a[32:35], v[96:99], v[64:79]
  ds_read_b128 v[108:111], v35 offset:256
  v_mfma_f32_32x32x16_bf16 v[80:95], a[160:163], v[96:99], v[80:95]
  v_xor_b32 v40, 128, v9
  s_add_u32 m0, s33, 8192
  s_nop 0
  global_load_lds_dwordx4 v40, s[14:15]
  s_add_u32 s14, s14, 1024
  s_addc_u32 s15, s15, 0
  s_waitcnt lgkmcnt(2)
  v_mfma_f32_32x32x16_bf16 v[64:79], a[36:39], v[100:103], v[64:79]
  ds_read_b128 v[96:99], v36 offset:256
  v_mfma_f32_32x32x16_bf16 v[80:95], a[164:167], v[100:103], v[80:95]
  v_xor_b32 v40, 144, v9
  s_add_u32 m0, s33, 9216
  s_nop 0
  global_load_lds_dwordx4 v40, s[14:15]
  s_add_u32 s14, s14, 1024
  s_addc_u32 s15, s15, 0
  s_waitcnt lgkmcnt(2)
  v_mfma_f32_32x32x16_bf16 v[64:79], a[40:43], v[104:107], v[64:79]
  ds_read_b128 v[100:103], v37 offset:256
  v_mfma_f32_32x32x16_bf16 v[80:95], a[168:171], v[104:107], v[80:95]
  v_xor_b32 v40, 160, v9
  s_add_u32 m0, s33, 10240
  s_nop 0
  global_load_lds_dwordx4 v40, s[14:15]
  s_add_u32 s14, s14, 1024
  s_addc_u32 s15, s15, 0
  s_waitcnt lgkmcnt(2)
  v_mfma_f32_32x32x16_bf16 v[64:79], a[44:47], v[108:111], v[64:79]
  ds_read_b128 v[104:107], v38 offset:256
  v_mfma_f32_32x32x16_bf16 v[80:95], a[172:175], v[108:111], v[80:95]
  v_xor_b32 v40, 176, v9
  s_add_u32 m0, s33, 11264
  s_nop 0
  global_load_lds_dwordx4 v40, s[14:15]
  s_add_u32 s14, s14, 1024
  s_addc_u32 s15, s15, 0
  s_waitcnt lgkmcnt(2)
  v_mfma_f32_32x32x16_bf16 v[64:79], a[48:51], v[96:99], v[64:79]
  ds_read_b128 v[108:111], v39 offset:256
  v_mfma_f32_32x32x16_bf16 v[80:95], a[176:179], v[96:99], v[80:95]
  v_xor_b32 v40, 192, v9
  s_add_u32 m0, s33, 12288
  s_nop 0
  global_load_lds_dwordx4 v40, s[14:15]
  s_add_u32 s14, s14, 1024
  s_addc_u32 s15, s15, 0
  s_waitcnt lgkmcnt(2)
  v_mfma_f32_32x32x16_bf16 v[64:79], a[52:55], v[100:103], v[64:79]
  ds_read_b128 v[96:99], v32 offset:512
  v_mfma_f32_32x32x16_bf16 v[80:95], a[180:183], v[100:103], v[80:95]
  v_xor_b32 v40, 208, v9
  s_add_u32 m0, s33, 13312
  s_nop 0
  global_load_lds_dwordx4 v40, s[14:15]
  s_add_u32 s14, s14, 1024
  s_addc_u32 s15, s15, 0
  s_waitcnt lgkmcnt(2)
  v_mfma_f32_32x32x16_bf16 v[64:79], a[56:59], v[104:107], v[64:79]
  ds_read_b128 v[100:103], v33 offset:512
  v_mfma_f32_32x32x16_bf16 v[80:95], a[184:187], v[104:107], v[80:95]
  v_xor_b32 v40, 224, v9
  s_add_u32 m0, s33, 14336
  s_nop 0
  global_load_lds_dwordx4 v40, s[14:15]
  s_add_u32 s14, s14, 1024
  s_addc_u32 s15, s15, 0
  s_waitcnt lgkmcnt(2)
  v_mfma_f32_32x32x16_bf16 v[64:79], a[60:63], v[108:111], v[64:79]
  ds_read_b128 v[104:107], v34 offset:512
  v_mfma_f32_32x32x16_bf16 v[80:95], a[188:191], v[108:111], v[80:95]
  v_xor_b32 v40, 240, v9
  s_add_u32 m0, s33, 15360
  s_nop 0
  global_load_lds_dwordx4 v40, s[14:15]
  s_add_u32 s14, s14, 1024
  s_addc_u32 s15, s15, 0
  s_waitcnt lgkmcnt(2)
  v_mfma_f32_32x32x16_bf16 v[64:79], a[64:67], v[96:99], v[64:79]
  ds_read_b128 v[108:111], v35 offset:512
  v_mfma_f32_32x32x16_bf16 v[80:95], a[192:195], v[96:99], v[80:95]
  s_waitcnt lgkmcnt(2)
  v_mfma_f32_32x32x16_bf16 v[64:79], a[68:71], v[100:103], v[64:79]
  ds_read_b128 v[96:99], v36 offset:512
  v_mfma_f32_32x32x16_bf16 v[80:95], a[196:199], v[100:103], v[80:95]
  s_waitcnt lgkmcnt(2)
  v_mfma_f32_32x32x16_bf16 v[64:79], a[72:75], v[104:107], v[64:79]
  ds_read_b128 v[100:103], v37 offset:512
  v_mfma_f32_32x32x16_bf16 v[80:95], a[200:203], v[104:107], v[80:95]
  s_waitcnt lgkmcnt(2)
  v_mfma_f32_32x32x16_bf16 v[64:79], a[76:79], v[108:111], v[64:79]
  ds_read_b128 v[104:107], v38 offset:512
  v_mfma_f32_32x32x16_bf16 v[80:95], a[204:207], v[108:111], v[80:95]
  s_waitcnt lgkmcnt(2)
  v_mfma_f32_32x32x16_bf16 v[64:79], a[80:83], v[96:99], v[64:79]
  ds_read_b128 v[108:111], v39 offset:512
  v_mfma_f32_32x32x16_bf16 v[80:95], a[208:211], v[96:99], v[80:95]
  s_waitcnt lgkmcnt(2)
  v_mfma_f32_32x32x16_bf16 v[64:79], a[84:87], v[100:103], v[64:79]
  ds_read_b128 v[96:99], v32 offset:768
  v_mfma_f32_32x32x16_bf16 v[80:95], a[212:215], v[100:103], v[80:95]
  s_waitcnt lgkmcnt(2)
  v_mfma_f32_32x32x16_bf16 v[64:79], a[88:91], v[104:107], v[64:79]
  ds_read_b128 v[100:103], v33 offset:768
  v_mfma_f32_32x32x16_bf16 v[80:95], a[216:219], v[104:107], v[80:95]
  s_waitcnt lgkmcnt(2)
  v_mfma_f32_32x32x16_bf16 v[64:79], a[92:95], v[108:111], v[64:79]
  ds_read_b128 v[104:107], v34 offset:768
  v_mfma_f32_32x32x16_bf16 v[80:95], a[220:223], v[108:111], v[80:95]
  s_waitcnt lgkmcnt(2)
  v_mfma_f32_32x32x16_bf16 v[64:79], a[96:99], v[96:99], v[64:79]
  ds_read_b128 v[108:111], v35 offset:768
  v_mfma_f32_32x32x16_bf16 v[80:95], a[224:227], v[96:99], v[80:95]
  s_waitcnt lgkmcnt(2)
  v_mfma_f32_32x32x16_bf16 v[64:79], a[100:103], v[100:103], v[64:79]
  ds_read_b128 v[96:99], v36 offset:768
  v_mfma_f32_32x32x16_bf16 v[80:95], a[228:231], v[100:103], v[80:95]
  s_waitcnt lgkmcnt(2)
  v_mfma_f32_32x32x16_bf16 v[64:79], a[104:107], v[104:107], v[64:79]
  ds_read_b128 v[100:103], v37 offset:768
  v_mfma_f32_32x32x16_bf16 v[80:95], a[232:235], v[104:107], v[80:95]
  s_waitcnt lgkmcnt(2)
  v_mfma_f32_32x32x16_bf16 v[64:79], a[108:111], v[108:111], v[64:79]
  ds_read_b128 v[104:107], v38 offset:768
  v_mfma_f32_32x32x16_bf16 v[80:95], a[236:239], v[108:111], v[80:95]
  s_waitcnt lgkmcnt(2)
  v_mfma_f32_32x32x16_bf16 v[64:79], a[112:115], v[96:99], v[64:79]
  ds_read_b128 v[108:111], v39 offset:768
  v_mfma_f32_32x32x16_bf16 v[80:95], a[240:243], v[96:99], v[80:95]
  s_waitcnt lgkmcnt(2)
  v_mfma_f32_32x32x16_bf16 v[64:79], a[116:119], v[100:103], v[64:79]
  v_mfma_f32_32x32x16_bf16 v[80:95], a[244:247], v[100:103], v[80:95]
  s_waitcnt lgkmcnt(1)
  v_mfma_f32_32x32x16_bf16 v[64:79], a[120:123], v[104:107], v[64:79]
  v_mfma_f32_32x32x16_bf16 v[80:95], a[248:251], v[104:107], v[80:95]
  s_waitcnt lgkmcnt(0)
  v_mfma_f32_32x32x16_bf16 v[64:79], a[124:127], v[108:111], v[64:79]
  v_mfma_f32_32x32x16_bf16 v[80:95], a[252:255], v[108:111], v[80:95]
  s_branch L_p_epi
L_p_kV:
  ds_read_b128 v[96:99], v32 offset:0
  ds_read_b128 v[100:103], v33 offset:0
  ds_read_b128 v[104:107], v34 offset:0
  s_waitcnt lgkmcnt(2)
  v_mfma_f32_32x32x16_bf16 v[64:79], v[96:99], a[0:3], v[64:79]
  ds_read_b128 v[108:111], v35 offset:0
  v_mfma_f32_32x32x16_bf16 v[80:95], v[96:99], a[128:131], v[80:95]
  v_xor_b32 v40, 0, v9
  s_add_u32 m0, s33, 0
  s_nop 0
  global_load_lds_dwordx4 v40, s[14:15]
  s_add_u32 s14, s14, 1024
  s_addc_u32 s15, s15, 0
  s_waitcnt lgkmcnt(2)
  v_mfma_f32_32x32x16_bf16 v[64:79], v[100:103], a[4:7], v[64:79]
  ds_read_b128 v[96:99], v36 offset:0
  v_mfma_f32_32x32x16_bf16 v[80:95], v[100:103], a[132:135], v[80:95]
  v_xor_b32 v40, 16, v9
  s_add_u32 m0, s33, 1024
  s_nop 0
  global_load_lds_dwordx4 v40, s[14:15]
  s_add_u32 s14, s14, 1024
  s_addc_u32 s15, s15, 0
  s_waitcnt lgkmcnt(2)
  v_mfma_f32_32x32x16_bf16 v[64:79], v[104:107], a[8:11], v[64:79]
  ds_read_b128 v[100:103], v37 offset:0
  v_mfma_f32_32x32x16_bf16 v[80:95], v[104:107], a[136:139], v[80:95]
  v_xor_b32 v40, 32, v9
  s_add_u32 m0, s33, 2048
  s_nop 0
  global_load_lds_dwordx4 v40, s[14:15]
  s_add_u32 s14, s14, 1024
  s_addc_u32 s15, s15, 0
  s_waitcnt lgkmcnt(2)
  v_mfma_f32_32x32x16_bf16 v[64:79], v[108:111], a[12:15], v[64:79]
  ds_read_b128 v[104:107], v38 offset:0
  v_mfma_f32_32x32x16_bf16 v[80:95], v[108:111], a[140:143], v[80:95]
  v_xor_b32 v40, 48, v9
  s_add_u32 m0, s33, 3072
  s_nop 0
  global_load_lds_dwordx4 v40, s[14:15]
  s_add_u32 s14, s14, 1024
  s_addc_u32 s15, s15, 0
  s_waitcnt lgkmcnt(2)
  v_mfma_f32_32x32x16_bf16 v[64:79], v[96:99], a[16:19], v[64:79]
  ds_read_b128 v[108:111], v39 offset:0
  v_mfma_f32_32x32x16_bf16 v[80:95], v[96:99], a[144:147], v[80:95]
  v_xor_b32 v40, 64, v9
  s_add_u32 m0, s33, 4096
  s_nop 0
  global_load_lds_dwordx4 v40, s[14:15]
  s_add_u32 s14, s14, 1024
  s_addc_u32 s15, s15, 0
  s_waitcnt lgkmcnt(2)
  v_mfma_f32_32x32x16_bf16 v[64:79], v[100:103], a[20:23], v[64:79]
  ds_read_b128 v[96:99], v32 offset:256
  v_mfma_f32_32x32x16_bf16 v[80:95], v[100:103], a[148:151], v[80:95]
  v_xor_b32 v40, 80, v9
  s_add_u32 m0, s33, 5120
  s_nop 0
  global_load_lds_dwordx4 v40, s[14:15]
  s_add_u32 s14, s14, 1024
  s_addc_u32 s15, s15, 0
  s_waitcnt lgkmcnt(2)
  v_mfma_f32_32x32x16_bf16 v[64:79], v[104:107], a[24:27], v[64:79]
  ds_read_b128 v[100:103], v33 offset:256
  v_mfma_f32_32x32x16_bf16 v[80:95], v[104:107], a[152:155], v[80:95]
  v_xor_b32 v40, 96, v9
  s_add_u32 m0, s33, 6144
  s_nop 0
  global_load_lds_dwordx4 v40, s[14:15]
  s_add_u32 s14, s14, 1024
  s_addc_u32 s15, s15, 0
  s_waitcnt lgkmcnt(2)
  v_mfma_f32_32x32x16_bf16 v[64:79], v[108:111], a[28:31], v[64:79]
  ds_read_b128 v[104:107], v34 offset:256
  v_mfma_f32_32x32x16_bf16 v[80:95], v[108:111], a[156:159], v[80:95]
  v_xor_b32 v40, 112, v9
  s_add_u32 m0, s33, 7168
  s_nop 0
  global_load_lds_dwordx4 v40, s[14:15]
  s_add_u32 s14, s14, 1024
  s_addc_u32 s15, s15, 0
  s_waitcnt lgkmcnt(2)
  v_mfma_f32_32x32x16_bf16 v[64:79], v[96:99], a[32:35], v[64:79]
  ds_read_b128 v[108:111], v35 offset:256
  v_mfma_f32_32x32x16_bf16 v[80:95], v[96:99], a[160:163], v[80:95]
  v_xor_b32 v40, 128, v9
  s_add_u32 m0, s33, 8192
  s_nop 0
  global_load_lds_dwordx4 v40, s[14:15]
  s_add_u32 s14, s14, 1024
  s_addc_u32 s15, s15, 0
  s_waitcnt lgkmcnt(2)
  v_mfma_f32_32x32x16_bf16 v[64:79], v[100:103], a[36:39], v[64:79]
  ds_read_b128 v[96:99], v36 offset:256
  v_mfma_f32_32x32x16_bf16 v[80:95], v[100:103], a[164:167], v[80:95]
  v_xor_b32 v40, 144, v9
  s_add_u32 m0, s33, 9216
  s_nop 0
  global_load_lds_dwordx4 v40, s[14:15]
  s_add_u32 s14, s14, 1024
  s_addc_u32 s15, s15, 0
  s_waitcnt lgkmcnt(2)
  v_mfma_f32_32x32x16_bf16 v[64:79], v[104:107], a[40:43], v[64:79]
  ds_read_b128 v[100:103], v37 offset:256
  v_mfma_f32_32x32x16_bf16 v[80:95], v[104:107], a[168:171], v[80:95]
  v_xor_b32 v40, 160, v9
  s_add_u32 m0, s33, 10240
  s_nop 0
  global_load_lds_dwordx4 v40, s[14:15]
  s_add_u32 s14, s14, 1024
  s_addc_u32 s15, s15, 0
  s_waitcnt lgkmcnt(2)
  v_mfma_f32_32x32x16_bf16 v[64:79], v[108:111], a[44:47], v[64:79]
  ds_read_b128 v[104:107], v38 offset:256
  v_mfma_f32_32x32x16_bf16 v[80:95], v[108:111], a[172:175], v[80:95]
  v_xor_b32 v40, 176, v9
  s_add_u32 m0, s33, 11264
  s_nop 0
  global_load_lds_dwordx4 v40, s[14:15]
  s_add_u32 s14, s14, 1024
  s_addc_u32 s15, s15, 0
  s_waitcnt lgkmcnt(2)
  v_mfma_f32_32x32x16_bf16 v[64:79], v[96:99], a[48:51], v[64:79]
  ds_read_b128 v[108:111], v39 offset:256
  v_mfma_f32_32x32x16_bf16 v[80:95], v[96:99], a[176:179], v[80:95]
  v_xor_b32 v40, 192, v9
  s_add_u32 m0, s33, 12288
  s_nop 0
  global_load_lds_dwordx4 v40, s[14:15]
  s_add_u32 s14, s14, 1024
  s_addc_u32 s15, s15, 0
  s_waitcnt lgkmcnt(2)
  v_mfma_f32_32x32x16_bf16 v[64:79], v[100:103], a[52:55], v[64:79]
  ds_read_b128 v[96:99], v32 offset:512
  v_mfma_f32_32x32x16_bf16 v[80:95], v[100:103], a[180:183], v[80:95]
  v_xor_b32 v40, 208, v9
  s_add_u32 m0, s33, 13312
  s_nop 0
  global_load_lds_dwordx4 v40, s[14:15]
  s_add_u32 s14, s14, 1024
  s_addc_u32 s15, s15, 0
  s_waitcnt lgkmcnt(2)
  v_mfma_f32_32x32x16_bf16 v[64:79], v[104:107], a[56:59], v[64:79]
  ds_read_b128 v[100:103], v33 offset:512
  v_mfma_f32_32x32x16_bf16 v[80:95], v[104:107], a[184:187], v[80:95]
  v_xor_b32 v40, 224, v9
  s_add_u32 m0, s33, 14336
  s_nop 0
  global_load_lds_dwordx4 v40, s[14:15]
  s_add_u32 s14, s14, 1024
  s_addc_u32 s15, s15, 0
  s_waitcnt lgkmcnt(2)
  v_mfma_f32_32x32x16_bf16 v[64:79], v[108:111], a[60:63], v[64:79]
  ds_read_b128 v[104:107], v34 offset:512
  v_mfma_f32_32x32x16_bf16 v[80:95], v[108:111], a[188:191], v[80:95]
  v_xor_b32 v40, 240, v9
  s_add_u32 m0, s33, 15360
  s_nop 0
  global_load_lds_dwordx4 v40, s[14:15]
  s_add_u32 s14, s14, 1024
  s_addc_u32 s15, s15, 0
  s_waitcnt lgkmcnt(2)
  v_mfma_f32_32x32x16_bf16 v[64:79], v[96:99], a[64:67], v[64:79]
  ds_read_b128 v[108:111], v35 offset:512
  v_mfma_f32_32x32x16_bf16 v[80:95], v[96:99], a[192:195], v[80:95]
  s_waitcnt lgkmcnt(2)
  v_mfma_f32_32x32x16_bf16 v[64:79], v[100:103], a[68:71], v[64:79]
  ds_read_b128 v[96:99], v36 offset:512
  v_mfma_f32_32x32x16_bf16 v[80:95], v[100:103], a[196:199], v[80:95]
  s_waitcnt lgkmcnt(2)
  v_mfma_f32_32x32x16_bf16 v[64:79], v[104:107], a[72:75], v[64:79]
  ds_read_b128 v[100:103], v37 offset:512
  v_mfma_f32_32x32x16_bf16 v[80:95], v[104:107], a[200:203], v[80:95]
  s_waitcnt lgkmcnt(2)
  v_mfma_f32_32x32x16_bf16 v[64:79], v[108:111], a[76:79], v[64:79]
  ds_read_b128 v[104:107], v38 offset:512
  v_mfma_f32_32x32x16_bf16 v[80:95], v[108:111], a[204:207], v[80:95]
  s_waitcnt lgkmcnt(2)
  v_mfma_f32_32x32x16_bf16 v[64:79], v[96:99], a[80:83], v[64:79]
  ds_read_b128 v[108:111], v39 offset:512
  v_mfma_f32_32x32x16_bf16 v[80:95], v[96:99], a[208:211], v[80:95]
  s_waitcnt lgkmcnt(2)
  v_mfma_f32_32x32x16_bf16 v[64:79], v[100:103], a[84:87], v[64:79]
  ds_read_b128 v[96:99], v32 offset:768
  v_mfma_f32_32x32x16_bf16 v[80:95], v[100:103], a[212:215], v[80:95]
  s_waitcnt lgkmcnt(2)
  v_mfma_f32_32x32x16_bf16 v[64:79], v[104:107], a[88:91], v[64:79]
  ds_read_b128 v[100:103], v33 offset:768
  v_mfma_f32_32x32x16_bf16 v[80:95], v[104:107], a[216:219], v[80:95]
  s_waitcnt lgkmcnt(2)
  v_mfma_f32_32x32x16_bf16 v[64:79], v[108:111], a[92:95], v[64:79]
  ds_read_b128 v[104:107], v34 offset:768
  v_mfma_f32_32x32x16_bf16 v[80:95], v[108:111], a[220:223], v[80:95]
  s_waitcnt lgkmcnt(2)
  v_mfma_f32_32x32x16_bf16 v[64:79], v[96:99], a[96:99], v[64:79]
  ds_read_b128 v[108:111], v35 offset:768
  v_mfma_f32_32x32x16_bf16 v[80:95], v[96:99], a[224:227], v[80:95]
  s_waitcnt lgkmcnt(2)
  v_mfma_f32_32x32x16_bf16 v[64:79], v[100:103], a[100:103], v[64:79]
  ds_read_b128 v[96:99], v36 offset:768
  v_mfma_f32_32x32x16_bf16 v[80:95], v[100:103], a[228:231], v[80:95]
  s_waitcnt lgkmcnt(2)
  v_mfma_f32_32x32x16_bf16 v[64:79], v[104:107], a[104:107], v[64:79]
  ds_read_b128 v[100:103], v37 offset:768
  v_mfma_f32_32x32x16_bf16 v[80:95], v[104:107], a[232:235], v[80:95]
  s_waitcnt lgkmcnt(2)
  v_mfma_f32_32x32x16_bf16 v[64:79], v[108:111], a[108:111], v[64:79]
  ds_read_b128 v[104:107], v38 offset:768
  v_mfma_f32_32x32x16_bf16 v[80:95], v[108:111], a[236:239], v[80:95]
  s_waitcnt lgkmcnt(2)
  v_mfma_f32_32x32x16_bf16 v[64:79], v[96:99], a[112:115], v[64:79]
  ds_read_b128 v[108:111], v39 offset:768
  v_mfma_f32_32x32x16_bf16 v[80:95], v[96:99], a[240:243], v[80:95]
  s_waitcnt lgkmcnt(2)
  v_mfma_f32_32x32x16_bf16 v[64:79], v[100:103], a[116:119], v[64:79]
  v_mfma_f32_32x32x16_bf16 v[80:95], v[100:103], a[244:247], v[80:95]
  s_waitcnt lgkmcnt(1)
  v_mfma_f32_32x32x16_bf16 v[64:79], v[104:107], a[120:123], v[64:79]
  v_mfma_f32_32x32x16_bf16 v[80:95], v[104:107], a[248:251], v[80:95]
  s_waitcnt lgkmcnt(0)
  v_mfma_f32_32x32x16_bf16 v[64:79], v[108:111], a[124:127], v[64:79]
  v_mfma_f32_32x32x16_bf16 v[80:95], v[108:111], a[252:255], v[80:95]
L_p_epi:
  s_nop 11
  v_cvt_pk_bf16_f32 v112, v64, v65
  v_cvt_pk_bf16_f32 v113, v66, v67
  v_cvt_pk_bf16_f32 v114, v68, v69
  v_cvt_pk_bf16_f32 v115, v70, v71
  v_cvt_pk_bf16_f32 v116, v72, v73
  v_cvt_pk_bf16_f32 v117, v74, v75
  v_cvt_pk_bf16_f32 v118, v76, v77
  v_cvt_pk_bf16_f32 v119, v78, v79
  v_cvt_pk_bf16_f32 v120, v80, v81
  v_cvt_pk_bf16_f32 v121, v82, v83
  v_cvt_pk_bf16_f32 v122, v84, v85
  v_cvt_pk_bf16_f32 v123, v86, v87
  v_cvt_pk_bf16_f32 v124, v88, v89
  v_cvt_pk_bf16_f32 v125, v90, v91
  v_cvt_pk_bf16_f32 v126, v92, v93
  v_cvt_pk_bf16_f32 v127, v94, v95
  s_cmp_eq_u32 s37, 3
  s_cbranch_scc0 L_p_norelu
  v_pk_max_i16 v112, v112, 0
  v_pk_max_i16 v113, v113, 0
  v_pk_max_i16 v114, v114, 0
  v_pk_max_i16 v115, v115, 0
  v_pk_max_i16 v116, v116, 0
  v_pk_max_i16 v117, v117, 0
  v_pk_max_i16 v118, v118, 0
  v_pk_max_i16 v119, v119, 0
  v_pk_max_i16 v120, v120, 0
  v_pk_max_i16 v121, v121, 0
  v_pk_max_i16 v122, v122, 0
  v_pk_max_i16 v123, v123, 0
  v_pk_max_i16 v124, v124, 0
  v_pk_max_i16 v125, v125, 0
  v_pk_max_i16 v126, v126, 0
  v_pk_max_i16 v127, v127, 0
L_p_norelu:
  v_permlane32_swap_b32 v112, v114
  v_permlane32_swap_b32 v113, v115
  v_permlane32_swap_b32 v116, v118
  v_permlane32_swap_b32 v117, v119
  v_permlane32_swap_b32 v120, v122
  v_permlane32_swap_b32 v121, v123
  v_permlane32_swap_b32 v124, v126
  v_permlane32_swap_b32 v125, v127
  s_waitcnt vmcnt(0)
  s_cmp_eq_u32 s37, 1
  s_cbranch_scc1 L_p_stV
  s_cmp_eq_u32 s37, 3
  s_cbranch_scc1 L_p_stH
  global_store_dwordx4 v12, v[112:115], s[42:43] offset:0 sc1
  global_store_dwordx4 v12, v[116:119], s[42:43] offset:512 sc1
  global_store_dwordx4 v12, v[120:123], s[42:43] offset:1024 sc1
  global_store_dwordx4 v12, v[124:127], s[42:43] offset:1536 sc1
  s_branch L_p_std
L_p_stV:
  v_permlane32_swap_b32 v112, v116
  v_permlane32_swap_b32 v113, v117
  v_permlane32_swap_b32 v114, v118
  v_permlane32_swap_b32 v115, v119
  v_permlane16_swap_b32 v112, v116
  v_permlane16_swap_b32 v113, v117
  v_permlane16_swap_b32 v114, v118
  v_permlane16_swap_b32 v115, v119
  v_permlane32_swap_b32 v120, v124
  v_permlane32_swap_b32 v121, v125
  v_permlane32_swap_b32 v122, v126
  v_permlane32_swap_b32 v123, v127
  v_permlane16_swap_b32 v120, v124
  v_permlane16_swap_b32 v121, v125
  v_permlane16_swap_b32 v122, v126
  v_permlane16_swap_b32 v123, v127
  global_store_dwordx4 v12, v[112:115], s[42:43] offset:0 sc1
  global_store_dwordx4 v12, v[116:119], s[42:43] offset:1024 sc1
  global_store_dwordx4 v12, v[120:123], s[42:43] offset:2048 sc1
  global_store_dwordx4 v12, v[124:127], s[42:43] offset:3072 sc1
  s_branch L_p_std
L_p_stH:
  global_store_dwordx4 v12, v[112:115], s[42:43] offset:0 sc1
  global_store_dwordx4 v12, v[116:119], s[42:43] offset:1024 sc1
  global_store_dwordx4 v12, v[120:123], s[42:43] offset:2048 sc1
  global_store_dwordx4 v12, v[124:127], s[42:43] offset:3072 sc1
L_p_std:
  s_cmp_eq_u32 s38, 0
  s_cbranch_scc0 L_p_nofirst
  s_waitcnt vmcnt(0)
  s_barrier
  s_cmp_eq_u32 s4, 0
  s_cbranch_scc0 L_p_nofirst
  v_mov_b32 v17, s45
  v_mov_b32 v18, 1
  s_mov_b64 exec, 1
  global_atomic_add v17, v18, s[8:9] sc1
  s_mov_b64 exec, -1
L_p_nofirst:
  s_add_u32 s42, s42, s44
  s_addc_u32 s43, s43, 0
  v_xor_b32 v32, 0x10000, v32
  v_xor_b32 v33, 0x10000, v33
  v_xor_b32 v34, 0x10000, v34
  v_xor_b32 v35, 0x10000, v35
  v_xor_b32 v36, 0x10000, v36
  v_xor_b32 v37, 0x10000, v37
  v_xor_b32 v38, 0x10000, v38
  v_xor_b32 v39, 0x10000, v39
  s_xor_b32 s19, s19, 0x10000
  s_add_u32 s38, s38, 1
  s_mov_b32 s32, 114688
  s_cmp_lt_u32 s38, 15
  s_cselect_b32 s32, s32, -16384
  s_ashr_i32 s30, s32, 31
  s_add_u32 s14, s14, s32
  s_addc_u32 s15, s15, s30
  s_cmp_lt_u32 s38, 16
  s_cbranch_scc1 L_p_it
  s_waitcnt vmcnt(0)
  s_barrier
  s_cmp_eq_u32 s4, 0
  s_cbranch_scc0 L_p_nosig2
  s_add_u32 s47, s45, 1792
  v_mov_b32 v17, s47
  v_mov_b32 v18, 1
  s_mov_b64 exec, 1
  global_atomic_add v17, v18, s[8:9] sc1
  global_atomic_add v17, v18, s[8:9] offset:128 sc1
  s_mov_b64 exec, -1
L_p_nosig2:
  s_branch L_role2
L_gate:
  s_sub_u32 s5, s12, 220
  v_and_b32 v1, 63, v0
  v_and_b32 v2, 31, v1
  v_lshrrev_b32 v3, 5, v1
  s_load_dwordx2 s[12:13], s[0:1], 80
  s_load_dwordx2 s[14:15], s[0:1], 0
  v_lshlrev_b32 v4, 4, v3
  v_lshl_add_u32 v5, v2, 10, v4
  s_lshl_b32 s16, s5, 2
  s_add_u32 s16, s16, s4
  s_lshl_b32 s16, s16, 2
  s_waitcnt lgkmcnt(0)
  s_load_dwordx2 s[22:23], s[0:1], 40
  s_lshl_b32 s24, s5, 2
  s_add_u32 s24, s24, s4
  s_lshl_b32 s24, s24, 18
  v_lshlrev_b32 v7, 7, v1
  v_add_u32 v7, s24, v7
  s_waitcnt lgkmcnt(0)
  global_load_dword v80, v7, s[22:23]
  v_add_u32 v7, 0x2000, v7
  global_load_dword v81, v7, s[22:23]
  v_add_u32 v7, 0x2000, v7
  global_load_dword v82, v7, s[22:23]
  v_add_u32 v7, 0x2000, v7
  global_load_dword v83, v7, s[22:23]
  v_add_u32 v7, 0x2000, v7
  global_load_dword v84, v7, s[22:23]
  v_add_u32 v7, 0x2000, v7
  global_load_dword v85, v7, s[22:23]
  v_add_u32 v7, 0x2000, v7
  global_load_dword v86, v7, s[22:23]
  v_add_u32 v7, 0x2000, v7
  global_load_dword v87, v7, s[22:23]
  v_add_u32 v7, 0x2000, v7
  global_load_dword v88, v7, s[22:23]
  v_add_u32 v7, 0x2000, v7
  global_load_dword v89, v7, s[22:23]
  v_add_u32 v7, 0x2000, v7
  global_load_dword v90, v7, s[22:23]
  v_add_u32 v7, 0x2000, v7
  global_load_dword v91, v7, s[22:23]
  v_add_u32 v7, 0x2000, v7
  global_load_dword v92, v7, s[22:23]
  v_add_u32 v7, 0x2000, v7
  global_load_dword v93, v7, s[22:23]
  v_add_u32 v7, 0x2000, v7
  global_load_dword v94, v7, s[22:23]
  v_add_u32 v7, 0x2000, v7
  global_load_dword v95, v7, s[22:23]
  v_add_u32 v7, 0x2000, v7
  global_load_dword v96, v7, s[22:23]
  v_add_u32 v7, 0x2000, v7
  global_load_dword v97, v7, s[22:23]
  v_add_u32 v7, 0x2000, v7
  global_load_dword v98, v7, s[22:23]
  v_add_u32 v7, 0x2000, v7
  global_load_dword v99, v7, s[22:23]
  v_add_u32 v7, 0x2000, v7
  global_load_dword v100, v7, s[22:23]
  v_add_u32 v7, 0x2000, v7
  global_load_dword v101, v7, s[22:23]
  v_add_u32 v7, 0x2000, v7
  global_load_dword v102, v7, s[22:23]
  v_add_u32 v7, 0x2000, v7
  global_load_dword v103, v7, s[22:23]
  v_add_u32 v7, 0x2000, v7
  global_load_dword v104, v7, s[22:23]
  v_add_u32 v7, 0x2000, v7
  global_load_dword v105, v7, s[22:23]
  v_add_u32 v7, 0x2000, v7
  global_load_dword v106, v7, s[22:23]
  v_add_u32 v7, 0x2000, v7
  global_load_dword v107, v7, s[22:23]
  v_add_u32 v7, 0x2000, v7
  global_load_dword v108, v7, s[22:23]
  v_add_u32 v7, 0x2000, v7
  global_load_dword v109, v7, s[22:23]
  v_add_u32 v7, 0x2000, v7
  global_load_dword v110, v7, s[22:23]
  v_add_u32 v7, 0x2000, v7
  global_load_dword v111, v7, s[22:23]
  v_add_u32 v7, 0x2000, v7
  global_load_dwordx4 v[128:131], v4, s[12:13] offset:0
  global_load_dwordx4 v[132:135], v4, s[12:13] offset:32
  global_load_dwordx4 v[136:139], v4, s[12:13] offset:64
  global_load_dwordx4 v[140:143], v4, s[12:13] offset:96
  global_load_dwordx4 v[144:147], v4, s[12:13] offset:128
  global_load_dwordx4 v[148:151], v4, s[12:13] offset:160
  global_load_dwordx4 v[152:155], v4, s[12:13] offset:192
  global_load_dwordx4 v[156:159], v4, s[12:13] offset:224
  global_load_dwordx4 v[160:163], v4, s[12:13] offset:256
  global_load_dwordx4 v[164:167], v4, s[12:13] offset:288
  global_load_dwordx4 v[168:171], v4, s[12:13] offset:320
  global_load_dwordx4 v[172:175], v4, s[12:13] offset:352
  global_load_dwordx4 v[176:179], v4, s[12:13] offset:384
  global_load_dwordx4 v[180:183], v4, s[12:13] offset:416
  global_load_dwordx4 v[184:187], v4, s[12:13] offset:448
  global_load_dwordx4 v[188:191], v4, s[12:13] offset:480
  global_load_dwordx4 v[192:195], v4, s[12:13] offset:512
  global_load_dwordx4 v[196:199], v4, s[12:13] offset:544
  global_load_dwordx4 v[200:203], v4, s[12:13] offset:576
  global_load_dwordx4 v[204:207], v4, s[12:13] offset:608
  global_load_dwordx4 v[208:211], v4, s[12:13] offset:640
  global_load_dwordx4 v[212:215], v4, s[12:13] offset:672
  global_load_dwordx4 v[216:219], v4, s[12:13] offset:704
  global_load_dwordx4 v[220:223], v4, s[12:13] offset:736
  global_load_dwordx4 v[224:227], v4, s[12:13] offset:768
  global_load_dwordx4 v[228:231], v4, s[12:13] offset:800
  global_load_dwordx4 v[232:235], v4, s[12:13] offset:832
  global_load_dwordx4 v[236:239], v4, s[12:13] offset:864
  global_load_dwordx4 v[240:243], v4, s[12:13] offset:896
  global_load_dwordx4 v[244:247], v4, s[12:13] offset:928
  global_load_dwordx4 v[248:251], v4, s[12:13] offset:960
  global_load_dwordx4 v[252:255], v4, s[12:13] offset:992
  s_mov_b32 s17, 0
L_g_it:
  s_add_u32 s18, s16, s17
  s_lshl_b32 s19, s18, 15
  s_add_u32 s20, s14, s19
  s_addc_u32 s21, s15, 0
  global_load_dwordx4 a[0:3], v5, s[20:21] offset:0
  global_load_dwordx4 a[4:7], v5, s[20:21] offset:32
  global_load_dwordx4 a[8:11], v5, s[20:21] offset:64
  global_load_dwordx4 a[12:15], v5, s[20:21] offset:96
  global_load_dwordx4 a[16:19], v5, s[20:21] offset:128
  global_load_dwordx4 a[20:23], v5, s[20:21] offset:160
  global_load_dwordx4 a[24:27], v5, s[20:21] offset:192
  global_load_dwordx4 a[28:31], v5, s[20:21] offset:224
  global_load_dwordx4 a[32:35], v5, s[20:21] offset:256
  global_load_dwordx4 a[36:39], v5, s[20:21] offset:288
  global_load_dwordx4 a[40:43], v5, s[20:21] offset:320
  global_load_dwordx4 a[44:47], v5, s[20:21] offset:352
  global_load_dwordx4 a[48:51], v5, s[20:21] offset:384
  global_load_dwordx4 a[52:55], v5, s[20:21] offset:416
  global_load_dwordx4 a[56:59], v5, s[20:21] offset:448
  global_load_dwordx4 a[60:63], v5, s[20:21] offset:480
  global_load_dwordx4 a[64:67], v5, s[20:21] offset:512
  global_load_dwordx4 a[68:71], v5, s[20:21] offset:544
  global_load_dwordx4 a[72:75], v5, s[20:21] offset:576
  global_load_dwordx4 a[76:79], v5, s[20:21] offset:608
  global_load_dwordx4 a[80:83], v5, s[20:21] offset:640
  global_load_dwordx4 a[84:87], v5, s[20:21] offset:672
  global_load_dwordx4 a[88:91], v5, s[20:21] offset:704
  global_load_dwordx4 a[92:95], v5, s[20:21] offset:736
  global_load_dwordx4 a[96:99], v5, s[20:21] offset:768
  global_load_dwordx4 a[100:103], v5, s[20:21] offset:800
  global_load_dwordx4 a[104:107], v5, s[20:21] offset:832
  global_load_dwordx4 a[108:111], v5, s[20:21] offset:864
  global_load_dwordx4 a[112:115], v5, s[20:21] offset:896
  global_load_dwordx4 a[116:119], v5, s[20:21] offset:928
  global_load_dwordx4 a[120:123], v5, s[20:21] offset:960
  global_load_dwordx4 a[124:127], v5, s[20:21] offset:992
  s_waitcnt vmcnt(0)
  v_mfma_f32_32x32x16_bf16 v[64:79], v[128:131], a[0:3], 0
  v_mfma_f32_32x32x16_bf16 v[64:79], v[132:135], a[4:7], v[64:79]
  v_mfma_f32_32x32x16_bf16 v[64:79], v[136:139], a[8:11], v[64:79]
  v_mfma_f32_32x32x16_bf16 v[64:79], v[140:143], a[12:15], v[64:79]
  v_mfma_f32_32x32x16_bf16 v[64:79], v[144:147], a[16:19], v[64:79]
  v_mfma_f32_32x32x16_bf16 v[64:79], v[148:151], a[20:23], v[64:79]
  v_mfma_f32_32x32x16_bf16 v[64:79], v[152:155], a[24:27], v[64:79]
  v_mfma_f32_32x32x16_bf16 v[64:79], v[156:159], a[28:31], v[64:79]
  v_mfma_f32_32x32x16_bf16 v[64:79], v[160:163], a[32:35], v[64:79]
  v_mfma_f32_32x32x16_bf16 v[64:79], v[164:167], a[36:39], v[64:79]
  v_mfma_f32_32x32x16_bf16 v[64:79], v[168:171], a[40:43], v[64:79]
  v_mfma_f32_32x32x16_bf16 v[64:79], v[172:175], a[44:47], v[64:79]
  v_mfma_f32_32x32x16_bf16 v[64:79], v[176:179], a[48:51], v[64:79]
  v_mfma_f32_32x32x16_bf16 v[64:79], v[180:183], a[52:55], v[64:79]
  v_mfma_f32_32x32x16_bf16 v[64:79], v[184:187], a[56:59], v[64:79]
  v_mfma_f32_32x32x16_bf16 v[64:79], v[188:191], a[60:63], v[64:79]
  v_mfma_f32_32x32x16_bf16 v[64:79], v[192:195], a[64:67], v[64:79]
  v_mfma_f32_32x32x16_bf16 v[64:79], v[196:199], a[68:71], v[64:79]
  v_mfma_f32_32x32x16_bf16 v[64:79], v[200:203], a[72:75], v[64:79]
  v_mfma_f32_32x32x16_bf16 v[64:79], v[204:207], a[76:79], v[64:79]
  v_mfma_f32_32x32x16_bf16 v[64:79], v[208:211], a[80:83], v[64:79]
  v_mfma_f32_32x32x16_bf16 v[64:79], v[212:215], a[84:87], v[64:79]
  v_mfma_f32_32x32x16_bf16 v[64:79], v[216:219], a[88:91], v[64:79]
  v_mfma_f32_32x32x16_bf16 v[64:79], v[220:223], a[92:95], v[64:79]
  v_mfma_f32_32x32x16_bf16 v[64:79], v[224:227], a[96:99], v[64:79]
  v_mfma_f32_32x32x16_bf16 v[64:79], v[228:231], a[100:103], v[64:79]
  v_mfma_f32_32x32x16_bf16 v[64:79], v[232:235], a[104:107], v[64:79]
  v_mfma_f32_32x32x16_bf16 v[64:79], v[236:239], a[108:111], v[64:79]
  v_mfma_f32_32x32x16_bf16 v[64:79], v[240:243], a[112:115], v[64:79]
  v_mfma_f32_32x32x16_bf16 v[64:79], v[244:247], a[116:119], v[64:79]
  v_mfma_f32_32x32x16_bf16 v[64:79], v[248:251], a[120:123], v[64:79]
  v_mfma_f32_32x32x16_bf16 v[64:79], v[252:255], a[124:127], v[64:79]
  s_nop 11
  v_mul_f32 v64, 0xbfb8aa3b, v64
  v_exp_f32 v64, v64
  s_nop 0
  v_add_f32 v64, 1.0, v64
  v_rcp_f32 v64, v64
  s_lshl_b32 s19, s18, 7
  s_add_u32 s19, s19, 89128960
  v_lshl_add_u32 v6, v2, 2, s19
  s_mov_b32 exec_hi, 0
  global_store_dword v6, v64, s[8:9] sc1
  s_mov_b32 exec_hi, -1
  s_add_u32 s17, s17, 1
  s_cmp_lt_u32 s17, 4
  s_cbranch_scc1 L_g_it
  s_waitcnt vmcnt(0)
  s_barrier
  s_mov_b32 s47, 0
L_g_wr:
  v_mov_b32 v17, 4
  global_load_dword v18, v17, s[10:11] sc1
  s_waitcnt vmcnt(0)
  v_readfirstlane_b32 s46, v18
  s_nop 0
  s_cmp_ge_u32 s46, 32
  s_cbranch_scc1 L_g_wrd
  s_add_u32 s47, s47, 1
  s_cmp_gt_u32 s47, 200000
  s_cbranch_scc1 L_g_wrd
  s_sleep 4
  s_branch L_g_wr
L_g_wrd:
  s_cmp_eq_u32 s4, 0
  s_cbranch_scc0 L_g_nosig
  v_mov_b32 v17, 596992
  v_mov_b32 v18, 1
  s_mov_b64 exec, 1
  global_atomic_add v17, v18, s[8:9] sc1
  s_mov_b64 exec, -1
L_g_nosig:
L_role2:
  s_barrier
  s_cmp_le_u32 s98, 4
  s_cbranch_scc0 L_isattn_hi
  s_cmp_lt_u32 s99, 16
  s_cbranch_scc0 L_isattn_lo
  s_mov_b32 s5, s99
  s_sub_u32 s6, s98, 1
  s_mov_b32 s7, 4
  v_and_b32 v1, 63, v0
  s_load_dwordx2 s[12:13], s[0:1], 40
  s_load_dwordx2 s[14:15], s[0:1], 72
  s_load_dwordx2 s[16:17], s[0:1], 88
  v_lshrrev_b32 v2, 2, v1
  v_lshlrev_b32 v2, 10, v2
  v_and_b32 v3, 3, v1
  v_lshl_add_u32 v2, v3, 4, v2
  s_lshl_b32 s18, s5, 6
  v_add_u32 v2, s18, v2
  v_lshrrev_b32 v4, 5, v1
  v_bfe_u32 v5, v1, 2, 2
  v_lshl_add_u32 v4, v4, 3, v5
  v_lshlrev_b32 v4, 6, v4
  v_bfe_u32 v5, v1, 4, 1
  v_lshl_add_u32 v4, v5, 5, v4
  v_lshl_add_u32 v4, v3, 3, v4
  s_lshl_b32 s19, s4, 15
  v_add_u32 v4, s19, v4
  s_waitcnt lgkmcnt(0)
  s_lshl_b32 s22, s4, 20
  s_add_u32 s22, s22, 0
  s_add_u32 s20, s12, s22
  s_addc_u32 s21, s13, 0
  s_add_u32 m0, s19, 0
  s_nop 0
  global_load_lds_dwordx4 v2, s[20:21]
  s_add_u32 s20, s20, 16384
  s_addc_u32 s21, s21, 0
  s_add_u32 m0, s19, 1024
  s_nop 0
  global_load_lds_dwordx4 v2, s[20:21]
  s_add_u32 s20, s20, 16384
  s_addc_u32 s21, s21, 0
  s_add_u32 m0, s19, 2048
  s_nop 0
  global_load_lds_dwordx4 v2, s[20:21]
  s_add_u32 s20, s20, 16384
  s_addc_u32 s21, s21, 0
  s_add_u32 m0, s19, 3072
  s_nop 0
  global_load_lds_dwordx4 v2, s[20:21]
  s_add_u32 s20, s20, 16384
  s_addc_u32 s21, s21, 0
  s_add_u32 m0, s19, 4096
  s_nop 0
  global_load_lds_dwordx4 v2, s[20:21]
  s_add_u32 s20, s20, 16384
  s_addc_u32 s21, s21, 0
  s_add_u32 m0, s19, 5120
  s_nop 0
  global_load_lds_dwordx4 v2, s[20:21]
  s_add_u32 s20, s20, 16384
  s_addc_u32 s21, s21, 0
  s_add_u32 m0, s19, 6144
  s_nop 0
  global_load_lds_dwordx4 v2, s[20:21]
  s_add_u32 s20, s20, 16384
  s_addc_u32 s21, s21, 0
  s_add_u32 m0, s19, 7168
  s_nop 0
  global_load_lds_dwordx4 v2, s[20:21]
  s_add_u32 s20, s20, 16384
  s_addc_u32 s21, s21, 0
  s_add_u32 m0, s19, 8192
  s_nop 0
  global_load_lds_dwordx4 v2, s[20:21]
  s_add_u32 s20, s20, 16384
  s_addc_u32 s21, s21, 0
  s_add_u32 m0, s19, 9216
  s_nop 0
  global_load_lds_dwordx4 v2, s[20:21]
  s_add_u32 s20, s20, 16384
  s_addc_u32 s21, s21, 0
  s_add_u32 m0, s19, 10240
  s_nop 0
  global_load_lds_dwordx4 v2, s[20:21]
  s_add_u32 s20, s20, 16384
  s_addc_u32 s21, s21, 0
  s_add_u32 m0, s19, 11264
  s_nop 0
  global_load_lds_dwordx4 v2, s[20:21]
  s_add_u32 s20, s20, 16384
  s_addc_u32 s21, s21, 0
  s_add_u32 m0, s19, 12288
  s_nop 0
  global_load_lds_dwordx4 v2, s[20:21]
  s_add_u32 s20, s20, 16384
  s_addc_u32 s21, s21, 0
  s_add_u32 m0, s19, 13312
  s_nop 0
  global_load_lds_dwordx4 v2, s[20:21]
  s_add_u32 s20, s20, 16384
  s_addc_u32 s21, s21, 0
  s_add_u32 m0, s19, 14336
  s_nop 0
  global_load_lds_dwordx4 v2, s[20:21]
  s_add_u32 s20, s20, 16384
  s_addc_u32 s21, s21, 0
  s_add_u32 m0, s19, 15360
  s_nop 0
  global_load_lds_dwordx4 v2, s[20:21]
  s_add_u32 s20, s20, 16384
  s_addc_u32 s21, s21, 0
  s_add_u32 m0, s19, 16384
  s_nop 0
  global_load_lds_dwordx4 v2, s[20:21]
  s_add_u32 s20, s20, 16384
  s_addc_u32 s21, s21, 0
  s_add_u32 m0, s19, 17408
  s_nop 0
  global_load_lds_dwordx4 v2, s[20:21]
  s_add_u32 s20, s20, 16384
  s_addc_u32 s21, s21, 0
  s_add_u32 m0, s19, 18432
  s_nop 0
  global_load_lds_dwordx4 v2, s[20:21]
  s_add_u32 s20, s20, 16384
  s_addc_u32 s21, s21, 0
  s_add_u32 m0, s19, 19456
  s_nop 0
  global_load_lds_dwordx4 v2, s[20:21]
  s_add_u32 s20, s20, 16384
  s_addc_u32 s21, s21, 0
  s_add_u32 m0, s19, 20480
  s_nop 0
  global_load_lds_dwordx4 v2, s[20:21]
  s_add_u32 s20, s20, 16384
  s_addc_u32 s21, s21, 0
  s_add_u32 m0, s19, 21504
  s_nop 0
  global_load_lds_dwordx4 v2, s[20:21]
  s_add_u32 s20, s20, 16384
  s_addc_u32 s21, s21, 0
  s_add_u32 m0, s19, 22528
  s_nop 0
  global_load_lds_dwordx4 v2, s[20:21]
  s_add_u32 s20, s20, 16384
  s_addc_u32 s21, s21, 0
  s_add_u32 m0, s19, 23552
  s_nop 0
  global_load_lds_dwordx4 v2, s[20:21]
  s_add_u32 s20, s20, 16384
  s_addc_u32 s21, s21, 0
  s_add_u32 m0, s19, 24576
  s_nop 0
  global_load_lds_dwordx4 v2, s[20:21]
  s_add_u32 s20, s20, 16384
  s_addc_u32 s21, s21, 0
  s_add_u32 m0, s19, 25600
  s_nop 0
  global_load_lds_dwordx4 v2, s[20:21]
  s_add_u32 s20, s20, 16384
  s_addc_u32 s21, s21, 0
  s_add_u32 m0, s19, 26624
  s_nop 0
  global_load_lds_dwordx4 v2, s[20:21]
  s_add_u32 s20, s20, 16384
  s_addc_u32 s21, s21, 0
  s_add_u32 m0, s19, 27648
  s_nop 0
  global_load_lds_dwordx4 v2, s[20:21]
  s_add_u32 s20, s20, 16384
  s_addc_u32 s21, s21, 0
  s_add_u32 m0, s19, 28672
  s_nop 0
  global_load_lds_dwordx4 v2, s[20:21]
  s_add_u32 s20, s20, 16384
  s_addc_u32 s21, s21, 0
  s_add_u32 m0, s19, 29696
  s_nop 0
  global_load_lds_dwordx4 v2, s[20:21]
  s_add_u32 s20, s20, 16384
  s_addc_u32 s21, s21, 0
  s_add_u32 m0, s19, 30720
  s_nop 0
  global_load_lds_dwordx4 v2, s[20:21]
  s_add_u32 s20, s20, 16384
  s_addc_u32 s21, s21, 0
  s_add_u32 m0, s19, 31744
  s_nop 0
  global_load_lds_dwordx4 v2, s[20:21]
  s_add_u32 s20, s20, 16384
  s_addc_u32 s21, s21, 0
  s_waitcnt vmcnt(0)
  ds_read_b64_tr_b16 a[0:1], v4 offset:0
  ds_read_b64_tr_b16 a[2:3], v4 offset:256
  ds_read_b64_tr_b16 a[4:5], v4 offset:1024
  ds_read_b64_tr_b16 a[6:7], v4 offset:1280
  ds_read_b64_tr_b16 a[8:9], v4 offset:2048
  ds_read_b64_tr_b16 a[10:11], v4 offset:2304
  ds_read_b64_tr_b16 a[12:13], v4 offset:3072
  ds_read_b64_tr_b16 a[14:15], v4 offset:3328
  ds_read_b64_tr_b16 a[16:17], v4 offset:4096
  ds_read_b64_tr_b16 a[18:19], v4 offset:4352
  ds_read_b64_tr_b16 a[20:21], v4 offset:5120
  ds_read_b64_tr_b16 a[22:23], v4 offset:5376
  s_waitcnt lgkmcnt(4)
  ds_read_b64_tr_b16 a[24:25], v4 offset:6144
  ds_read_b64_tr_b16 a[26:27], v4 offset:6400
  ds_read_b64_tr_b16 a[28:29], v4 offset:7168
  ds_read_b64_tr_b16 a[30:31], v4 offset:7424
  ds_read_b64_tr_b16 a[32:33], v4 offset:8192
  ds_read_b64_tr_b16 a[34:35], v4 offset:8448
  ds_read_b64_tr_b16 a[36:37], v4 offset:9216
  ds_read_b64_tr_b16 a[38:39], v4 offset:9472
  ds_read_b64_tr_b16 a[40:41], v4 offset:10240
  ds_read_b64_tr_b16 a[42:43], v4 offset:10496
  ds_read_b64_tr_b16 a[44:45], v4 offset:11264
  ds_read_b64_tr_b16 a[46:47], v4 offset:11520
  s_waitcnt lgkmcnt(4)
  ds_read_b64_tr_b16 a[48:49], v4 offset:12288
  ds_read_b64_tr_b16 a[50:51], v4 offset:12544
  ds_read_b64_tr_b16 a[52:53], v4 offset:13312
  ds_read_b64_tr_b16 a[54:55], v4 offset:13568
  ds_read_b64_tr_b16 a[56:57], v4 offset:14336
  ds_read_b64_tr_b16 a[58:59], v4 offset:14592
  ds_read_b64_tr_b16 a[60:61], v4 offset:15360
  ds_read_b64_tr_b16 a[62:63], v4 offset:15616
  ds_read_b64_tr_b16 a[64:65], v4 offset:16384
  ds_read_b64_tr_b16 a[66:67], v4 offset:16640
  ds_read_b64_tr_b16 a[68:69], v4 offset:17408
  ds_read_b64_tr_b16 a[70:71], v4 offset:17664
  s_waitcnt lgkmcnt(4)
  ds_read_b64_tr_b16 a[72:73], v4 offset:18432
  ds_read_b64_tr_b16 a[74:75], v4 offset:18688
  ds_read_b64_tr_b16 a[76:77], v4 offset:19456
  ds_read_b64_tr_b16 a[78:79], v4 offset:19712
  ds_read_b64_tr_b16 a[80:81], v4 offset:20480
  ds_read_b64_tr_b16 a[82:83], v4 offset:20736
  ds_read_b64_tr_b16 a[84:85], v4 offset:21504
  ds_read_b64_tr_b16 a[86:87], v4 offset:21760
  ds_read_b64_tr_b16 a[88:89], v4 offset:22528
  ds_read_b64_tr_b16 a[90:91], v4 offset:22784
  ds_read_b64_tr_b16 a[92:93], v4 offset:23552
  ds_read_b64_tr_b16 a[94:95], v4 offset:23808
  s_waitcnt lgkmcnt(4)
  ds_read_b64_tr_b16 a[96:97], v4 offset:24576
  ds_read_b64_tr_b16 a[98:99], v4 offset:24832
  ds_read_b64_tr_b16 a[100:101], v4 offset:25600
  ds_read_b64_tr_b16 a[102:103], v4 offset:25856
  ds_read_b64_tr_b16 a[104:105], v4 offset:26624
  ds_read_b64_tr_b16 a[106:107], v4 offset:26880
  ds_read_b64_tr_b16 a[108:109], v4 offset:27648
  ds_read_b64_tr_b16 a[110:111], v4 offset:27904
  ds_read_b64_tr_b16 a[112:113], v4 offset:28672
  ds_read_b64_tr_b16 a[114:115], v4 offset:28928
  ds_read_b64_tr_b16 a[116:117], v4 offset:29696
  ds_read_b64_tr_b16 a[118:119], v4 offset:29952
  s_waitcnt lgkmcnt(4)
  ds_read_b64_tr_b16 a[120:121], v4 offset:30720
  ds_read_b64_tr_b16 a[122:123], v4 offset:30976
  ds_read_b64_tr_b16 a[124:125], v4 offset:31744
  ds_read_b64_tr_b16 a[126:127], v4 offset:32000
  s_waitcnt lgkmcnt(0)
  s_lshl_b32 s22, s4, 20
  s_add_u32 s22, s22, 524288
  s_add_u32 s20, s12, s22
  s_addc_u32 s21, s13, 0
  s_add_u32 m0, s19, 0
  s_nop 0
  global_load_lds_dwordx4 v2, s[20:21]
  s_add_u32 s20, s20, 16384
  s_addc_u32 s21, s21, 0
  s_add_u32 m0, s19, 1024
  s_nop 0
  global_load_lds_dwordx4 v2, s[20:21]
  s_add_u32 s20, s20, 16384
  s_addc_u32 s21, s21, 0
  s_add_u32 m0, s19, 2048
  s_nop 0
  global_load_lds_dwordx4 v2, s[20:21]
  s_add_u32 s20, s20, 16384
  s_addc_u32 s21, s21, 0
  s_add_u32 m0, s19, 3072
  s_nop 0
  global_load_lds_dwordx4 v2, s[20:21]
  s_add_u32 s20, s20, 16384
  s_addc_u32 s21, s21, 0
  s_add_u32 m0, s19, 4096
  s_nop 0
  global_load_lds_dwordx4 v2, s[20:21]
  s_add_u32 s20, s20, 16384
  s_addc_u32 s21, s21, 0
  s_add_u32 m0, s19, 5120
  s_nop 0
  global_load_lds_dwordx4 v2, s[20:21]
  s_add_u32 s20, s20, 16384
  s_addc_u32 s21, s21, 0
  s_add_u32 m0, s19, 6144
  s_nop 0
  global_load_lds_dwordx4 v2, s[20:21]
  s_add_u32 s20, s20, 16384
  s_addc_u32 s21, s21, 0
  s_add_u32 m0, s19, 7168
  s_nop 0
  global_load_lds_dwordx4 v2, s[20:21]
  s_add_u32 s20, s20, 16384
  s_addc_u32 s21, s21, 0
  s_add_u32 m0, s19, 8192
  s_nop 0
  global_load_lds_dwordx4 v2, s[20:21]
  s_add_u32 s20, s20, 16384
  s_addc_u32 s21, s21, 0
  s_add_u32 m0, s19, 9216
  s_nop 0
  global_load_lds_dwordx4 v2, s[20:21]
  s_add_u32 s20, s20, 16384
  s_addc_u32 s21, s21, 0
  s_add_u32 m0, s19, 10240
  s_nop 0
  global_load_lds_dwordx4 v2, s[20:21]
  s_add_u32 s20, s20, 16384
  s_addc_u32 s21, s21, 0
  s_add_u32 m0, s19, 11264
  s_nop 0
  global_load_lds_dwordx4 v2, s[20:21]
  s_add_u32 s20, s20, 16384
  s_addc_u32 s21, s21, 0
  s_add_u32 m0, s19, 12288
  s_nop 0
  global_load_lds_dwordx4 v2, s[20:21]
  s_add_u32 s20, s20, 16384
  s_addc_u32 s21, s21, 0
  s_add_u32 m0, s19, 13312
  s_nop 0
  global_load_lds_dwordx4 v2, s[20:21]
  s_add_u32 s20, s20, 16384
  s_addc_u32 s21, s21, 0
  s_add_u32 m0, s19, 14336
  s_nop 0
  global_load_lds_dwordx4 v2, s[20:21]
  s_add_u32 s20, s20, 16384
  s_addc_u32 s21, s21, 0
  s_add_u32 m0, s19, 15360
  s_nop 0
  global_load_lds_dwordx4 v2, s[20:21]
  s_add_u32 s20, s20, 16384
  s_addc_u32 s21, s21, 0
  s_add_u32 m0, s19, 16384
  s_nop 0
  global_load_lds_dwordx4 v2, s[20:21]
  s_add_u32 s20, s20, 16384
  s_addc_u32 s21, s21, 0
  s_add_u32 m0, s19, 17408
  s_nop 0
  global_load_lds_dwordx4 v2, s[20:21]
  s_add_u32 s20, s20, 16384
  s_addc_u32 s21, s21, 0
  s_add_u32 m0, s19, 18432
  s_nop 0
  global_load_lds_dwordx4 v2, s[20:21]
  s_add_u32 s20, s20, 16384
  s_addc_u32 s21, s21, 0
  s_add_u32 m0, s19, 19456
  s_nop 0
  global_load_lds_dwordx4 v2, s[20:21]
  s_add_u32 s20, s20, 16384
  s_addc_u32 s21, s21, 0
  s_add_u32 m0, s19, 20480
  s_nop 0
  global_load_lds_dwordx4 v2, s[20:21]
  s_add_u32 s20, s20, 16384
  s_addc_u32 s21, s21, 0
  s_add_u32 m0, s19, 21504
  s_nop 0
  global_load_lds_dwordx4 v2, s[20:21]
  s_add_u32 s20, s20, 16384
  s_addc_u32 s21, s21, 0
  s_add_u32 m0, s19, 22528
  s_nop 0
  global_load_lds_dwordx4 v2, s[20:21]
  s_add_u32 s20, s20, 16384
  s_addc_u32 s21, s21, 0
  s_add_u32 m0, s19, 23552
  s_nop 0
  global_load_lds_dwordx4 v2, s[20:21]
  s_add_u32 s20, s20, 16384
  s_addc_u32 s21, s21, 0
  s_add_u32 m0, s19, 24576
  s_nop 0
  global_load_lds_dwordx4 v2, s[20:21]
  s_add_u32 s20, s20, 16384
  s_addc_u32 s21, s21, 0
  s_add_u32 m0, s19, 25600
  s_nop 0
  global_load_lds_dwordx4 v2, s[20:21]
  s_add_u32 s20, s20, 16384
  s_addc_u32 s21, s21, 0
  s_add_u32 m0, s19, 26624
  s_nop 0
  global_load_lds_dwordx4 v2, s[20:21]
  s_add_u32 s20, s20, 16384
  s_addc_u32 s21, s21, 0
  s_add_u32 m0, s19, 27648
  s_nop 0
  global_load_lds_dwordx4 v2, s[20:21]
  s_add_u32 s20, s20, 16384
  s_addc_u32 s21, s21, 0
  s_add_u32 m0, s19, 28672
  s_nop 0
  global_load_lds_dwordx4 v2, s[20:21]
  s_add_u32 s20, s20, 16384
  s_addc_u32 s21, s21, 0
  s_add_u32 m0, s19, 29696
  s_nop 0
  global_load_lds_dwordx4 v2, s[20:21]
  s_add_u32 s20, s20, 16384
  s_addc_u32 s21, s21, 0
  s_add_u32 m0, s19, 30720
  s_nop 0
  global_load_lds_dwordx4 v2, s[20:21]
  s_add_u32 s20, s20, 16384
  s_addc_u32 s21, s21, 0
  s_add_u32 m0, s19, 31744
  s_nop 0
  global_load_lds_dwordx4 v2, s[20:21]
  s_add_u32 s20, s20, 16384
  s_addc_u32 s21, s21, 0
  s_waitcnt vmcnt(0)
  ds_read_b64_tr_b16 a[128:129], v4 offset:0
  ds_read_b64_tr_b16 a[130:131], v4 offset:256
  ds_read_b64_tr_b16 a[132:133], v4 offset:1024
  ds_read_b64_tr_b16 a[134:135], v4 offset:1280
  ds_read_b64_tr_b16 a[136:137], v4 offset:2048
  ds_read_b64_tr_b16 a[138:139], v4 offset:2304
  ds_read_b64_tr_b16 a[140:141], v4 offset:3072
  ds_read_b64_tr_b16 a[142:143], v4 offset:3328
  ds_read_b64_tr_b16 a[144:145], v4 offset:4096
  ds_read_b64_tr_b16 a[146:147], v4 offset:4352
  ds_read_b64_tr_b16 a[148:149], v4 offset:5120
  ds_read_b64_tr_b16 a[150:151], v4 offset:5376
  s_waitcnt lgkmcnt(4)
  ds_read_b64_tr_b16 a[152:153], v4 offset:6144
  ds_read_b64_tr_b16 a[154:155], v4 offset:6400
  ds_read_b64_tr_b16 a[156:157], v4 offset:7168
  ds_read_b64_tr_b16 a[158:159], v4 offset:7424
  ds_read_b64_tr_b16 a[160:161], v4 offset:8192
  ds_read_b64_tr_b16 a[162:163], v4 offset:8448
  ds_read_b64_tr_b16 a[164:165], v4 offset:9216
  ds_read_b64_tr_b16 a[166:167], v4 offset:9472
  ds_read_b64_tr_b16 a[168:169], v4 offset:10240
  ds_read_b64_tr_b16 a[170:171], v4 offset:10496
  ds_read_b64_tr_b16 a[172:173], v4 offset:11264
  ds_read_b64_tr_b16 a[174:175], v4 offset:11520
  s_waitcnt lgkmcnt(4)
  ds_read_b64_tr_b16 a[176:177], v4 offset:12288
  ds_read_b64_tr_b16 a[178:179], v4 offset:12544
  ds_read_b64_tr_b16 a[180:181], v4 offset:13312
  ds_read_b64_tr_b16 a[182:183], v4 offset:13568
  ds_read_b64_tr_b16 a[184:185], v4 offset:14336
  ds_read_b64_tr_b16 a[186:187], v4 offset:14592
  ds_read_b64_tr_b16 a[188:189], v4 offset:15360
  ds_read_b64_tr_b16 a[190:191], v4 offset:15616
  ds_read_b64_tr_b16 a[192:193], v4 offset:16384
  ds_read_b64_tr_b16 a[194:195], v4 offset:16640
  ds_read_b64_tr_b16 a[196:197], v4 offset:17408
  ds_read_b64_tr_b16 a[198:199], v4 offset:17664
  s_waitcnt lgkmcnt(4)
  ds_read_b64_tr_b16 a[200:201], v4 offset:18432
  ds_read_b64_tr_b16 a[202:203], v4 offset:18688
  ds_read_b64_tr_b16 a[204:205], v4 offset:19456
  ds_read_b64_tr_b16 a[206:207], v4 offset:19712
  ds_read_b64_tr_b16 a[208:209], v4 offset:20480
  ds_read_b64_tr_b16 a[210:211], v4 offset:20736
  ds_read_b64_tr_b16 a[212:213], v4 offset:21504
  ds_read_b64_tr_b16 a[214:215], v4 offset:21760
  ds_read_b64_tr_b16 a[216:217], v4 offset:22528
  ds_read_b64_tr_b16 a[218:219], v4 offset:22784
  ds_read_b64_tr_b16 a[220:221], v4 offset:23552
  ds_read_b64_tr_b16 a[222:223], v4 offset:23808
  s_waitcnt lgkmcnt(4)
  ds_read_b64_tr_b16 a[224:225], v4 offset:24576
  ds_read_b64_tr_b16 a[226:227], v4 offset:24832
  ds_read_b64_tr_b16 a[228:229], v4 offset:25600
  ds_read_b64_tr_b16 a[230:231], v4 offset:25856
  ds_read_b64_tr_b16 a[232:233], v4 offset:26624
  ds_read_b64_tr_b16 a[234:235], v4 offset:26880
  ds_read_b64_tr_b16 a[236:237], v4 offset:27648
  ds_read_b64_tr_b16 a[238:239], v4 offset:27904
  ds_read_b64_tr_b16 a[240:241], v4 offset:28672
  ds_read_b64_tr_b16 a[242:243], v4 offset:28928
  ds_read_b64_tr_b16 a[244:245], v4 offset:29696
  ds_read_b64_tr_b16 a[246:247], v4 offset:29952
  s_waitcnt lgkmcnt(4)
  ds_read_b64_tr_b16 a[248:249], v4 offset:30720
  ds_read_b64_tr_b16 a[250:251], v4 offset:30976
  ds_read_b64_tr_b16 a[252:253], v4 offset:31744
  ds_read_b64_tr_b16 a[254:255], v4 offset:32000
  s_waitcnt lgkmcnt(0)
  s_mul_i32 s22, s4, 458752
  s_add_u32 s20, s14, s22
  s_addc_u32 s21, s15, 0
  s_add_u32 m0, s19, 0
  s_nop 0
  global_load_lds_dwordx4 v2, s[20:21]
  s_add_u32 s20, s20, 16384
  s_addc_u32 s21, s21, 0
  s_add_u32 m0, s19, 1024
  s_nop 0
  global_load_lds_dwordx4 v2, s[20:21]
  s_add_u32 s20, s20, 16384
  s_addc_u32 s21, s21, 0
  s_add_u32 m0, s19, 2048
  s_nop 0
  global_load_lds_dwordx4 v2, s[20:21]
  s_add_u32 s20, s20, 16384
  s_addc_u32 s21, s21, 0
  s_add_u32 m0, s19, 3072
  s_nop 0
  global_load_lds_dwordx4 v2, s[20:21]
  s_add_u32 s20, s20, 16384
  s_addc_u32 s21, s21, 0
  s_add_u32 m0, s19, 4096
  s_nop 0
  global_load_lds_dwordx4 v2, s[20:21]
  s_add_u32 s20, s20, 16384
  s_addc_u32 s21, s21, 0
  s_add_u32 m0, s19, 5120
  s_nop 0
  global_load_lds_dwordx4 v2, s[20:21]
  s_add_u32 s20, s20, 16384
  s_addc_u32 s21, s21, 0
  s_add_u32 m0, s19, 6144
  s_nop 0
  global_load_lds_dwordx4 v2, s[20:21]
  s_add_u32 s20, s20, 16384
  s_addc_u32 s21, s21, 0
  s_add_u32 m0, s19, 7168
  s_nop 0
  global_load_lds_dwordx4 v2, s[20:21]
  s_add_u32 s20, s20, 16384
  s_addc_u32 s21, s21, 0
  s_add_u32 m0, s19, 8192
  s_nop 0
  global_load_lds_dwordx4 v2, s[20:21]
  s_add_u32 s20, s20, 16384
  s_addc_u32 s21, s21, 0
  s_add_u32 m0, s19, 9216
  s_nop 0
  global_load_lds_dwordx4 v2, s[20:21]
  s_add_u32 s20, s20, 16384
  s_addc_u32 s21, s21, 0
  s_add_u32 m0, s19, 10240
  s_nop 0
  global_load_lds_dwordx4 v2, s[20:21]
  s_add_u32 s20, s20, 16384
  s_addc_u32 s21, s21, 0
  s_add_u32 m0, s19, 11264
  s_nop 0
  global_load_lds_dwordx4 v2, s[20:21]
  s_add_u32 s20, s20, 16384
  s_addc_u32 s21, s21, 0
  s_add_u32 m0, s19, 12288
  s_nop 0
  global_load_lds_dwordx4 v2, s[20:21]
  s_add_u32 s20, s20, 16384
  s_addc_u32 s21, s21, 0
  s_add_u32 m0, s19, 13312
  s_nop 0
  global_load_lds_dwordx4 v2, s[20:21]
  s_add_u32 s20, s20, 16384
  s_addc_u32 s21, s21, 0
  s_add_u32 m0, s19, 14336
  s_nop 0
  global_load_lds_dwordx4 v2, s[20:21]
  s_add_u32 s20, s20, 16384
  s_addc_u32 s21, s21, 0
  s_add_u32 m0, s19, 15360
  s_nop 0
  global_load_lds_dwordx4 v2, s[20:21]
  s_add_u32 s20, s20, 16384
  s_addc_u32 s21, s21, 0
  s_add_u32 m0, s19, 16384
  s_nop 0
  global_load_lds_dwordx4 v2, s[20:21]
  s_add_u32 s20, s20, 16384
  s_addc_u32 s21, s21, 0
  s_add_u32 m0, s19, 17408
  s_nop 0
  global_load_lds_dwordx4 v2, s[20:21]
  s_add_u32 s20, s20, 16384
  s_addc_u32 s21, s21, 0
  s_add_u32 m0, s19, 18432
  s_nop 0
  global_load_lds_dwordx4 v2, s[20:21]
  s_add_u32 s20, s20, 16384
  s_addc_u32 s21, s21, 0
  s_add_u32 m0, s19, 19456
  s_nop 0
  global_load_lds_dwordx4 v2, s[20:21]
  s_add_u32 s20, s20, 16384
  s_addc_u32 s21, s21, 0
  s_add_u32 m0, s19, 20480
  s_nop 0
  global_load_lds_dwordx4 v2, s[20:21]
  s_add_u32 s20, s20, 16384
  s_addc_u32 s21, s21, 0
  s_add_u32 m0, s19, 21504
  s_nop 0
  global_load_lds_dwordx4 v2, s[20:21]
  s_add_u32 s20, s20, 16384
  s_addc_u32 s21, s21, 0
  s_add_u32 m0, s19, 22528
  s_nop 0
  global_load_lds_dwordx4 v2, s[20:21]
  s_add_u32 s20, s20, 16384
  s_addc_u32 s21, s21, 0
  s_add_u32 m0, s19, 23552
  s_nop 0
  global_load_lds_dwordx4 v2, s[20:21]
  s_add_u32 s20, s20, 16384
  s_addc_u32 s21, s21, 0
  s_add_u32 m0, s19, 24576
  s_nop 0
  global_load_lds_dwordx4 v2, s[20:21]
  s_add_u32 s20, s20, 16384
  s_addc_u32 s21, s21, 0
  s_add_u32 m0, s19, 25600
  s_nop 0
  global_load_lds_dwordx4 v2, s[20:21]
  s_add_u32 s20, s20, 16384
  s_addc_u32 s21, s21, 0
  s_add_u32 m0, s19, 26624
  s_nop 0
  global_load_lds_dwordx4 v2, s[20:21]
  s_add_u32 s20, s20, 16384
  s_addc_u32 s21, s21, 0
  s_add_u32 m0, s19, 27648
  s_nop 0
  global_load_lds_dwordx4 v2, s[20:21]
  s_add_u32 s20, s20, 16384
  s_addc_u32 s21, s21, 0
  s_waitcnt vmcnt(0)
  ds_read_b64_tr_b16 v[128:129], v4 offset:0
  ds_read_b64_tr_b16 v[130:131], v4 offset:256
  ds_read_b64_tr_b16 v[132:133], v4 offset:1024
  ds_read_b64_tr_b16 v[134:135], v4 offset:1280
  ds_read_b64_tr_b16 v[136:137], v4 offset:2048
  ds_read_b64_tr_b16 v[138:139], v4 offset:2304
  ds_read_b64_tr_b16 v[140:141], v4 offset:3072
  ds_read_b64_tr_b16 v[142:143], v4 offset:3328
  ds_read_b64_tr_b16 v[144:145], v4 offset:4096
  ds_read_b64_tr_b16 v[146:147], v4 offset:4352
  ds_read_b64_tr_b16 v[148:149], v4 offset:5120
  ds_read_b64_tr_b16 v[150:151], v4 offset:5376
  s_waitcnt lgkmcnt(4)
  ds_read_b64_tr_b16 v[152:153], v4 offset:6144
  ds_read_b64_tr_b16 v[154:155], v4 offset:6400
  ds_read_b64_tr_b16 v[156:157], v4 offset:7168
  ds_read_b64_tr_b16 v[158:159], v4 offset:7424
  ds_read_b64_tr_b16 v[160:161], v4 offset:8192
  ds_read_b64_tr_b16 v[162:163], v4 offset:8448
  ds_read_b64_tr_b16 v[164:165], v4 offset:9216
  ds_read_b64_tr_b16 v[166:167], v4 offset:9472
  ds_read_b64_tr_b16 v[168:169], v4 offset:10240
  ds_read_b64_tr_b16 v[170:171], v4 offset:10496
  ds_read_b64_tr_b16 v[172:173], v4 offset:11264
  ds_read_b64_tr_b16 v[174:175], v4 offset:11520
  s_waitcnt lgkmcnt(4)
  ds_read_b64_tr_b16 v[176:177], v4 offset:12288
  ds_read_b64_tr_b16 v[178:179], v4 offset:12544
  ds_read_b64_tr_b16 v[180:181], v4 offset:13312
  ds_read_b64_tr_b16 v[182:183], v4 offset:13568
  ds_read_b64_tr_b16 v[184:185], v4 offset:14336
  ds_read_b64_tr_b16 v[186:187], v4 offset:14592
  ds_read_b64_tr_b16 v[188:189], v4 offset:15360
  ds_read_b64_tr_b16 v[190:191], v4 offset:15616
  ds_read_b64_tr_b16 v[192:193], v4 offset:16384
  ds_read_b64_tr_b16 v[194:195], v4 offset:16640
  ds_read_b64_tr_b16 v[196:197], v4 offset:17408
  ds_read_b64_tr_b16 v[198:199], v4 offset:17664
  s_waitcnt lgkmcnt(4)
  ds_read_b64_tr_b16 v[200:201], v4 offset:18432
  ds_read_b64_tr_b16 v[202:203], v4 offset:18688
  ds_read_b64_tr_b16 v[204:205], v4 offset:19456
  ds_read_b64_tr_b16 v[206:207], v4 offset:19712
  ds_read_b64_tr_b16 v[208:209], v4 offset:20480
  ds_read_b64_tr_b16 v[210:211], v4 offset:20736
  ds_read_b64_tr_b16 v[212:213], v4 offset:21504
  ds_read_b64_tr_b16 v[214:215], v4 offset:21760
  ds_read_b64_tr_b16 v[216:217], v4 offset:22528
  ds_read_b64_tr_b16 v[218:219], v4 offset:22784
  ds_read_b64_tr_b16 v[220:221], v4 offset:23552
  ds_read_b64_tr_b16 v[222:223], v4 offset:23808
  s_waitcnt lgkmcnt(4)
  ds_read_b64_tr_b16 v[224:225], v4 offset:24576
  ds_read_b64_tr_b16 v[226:227], v4 offset:24832
  ds_read_b64_tr_b16 v[228:229], v4 offset:25600
  ds_read_b64_tr_b16 v[230:231], v4 offset:25856
  ds_read_b64_tr_b16 v[232:233], v4 offset:26624
  ds_read_b64_tr_b16 v[234:235], v4 offset:26880
  ds_read_b64_tr_b16 v[236:237], v4 offset:27648
  ds_read_b64_tr_b16 v[238:239], v4 offset:27904
  s_waitcnt lgkmcnt(0)
  v_lshlrev_b32 v6, 4, v1
  s_lshl_b32 s19, s4, 12
  v_add_u32 v6, s19, v6
  v_and_b32 v7, 7, v1
  v_bfe_u32 v8, v1, 3, 2
  v_lshrrev_b32 v9, 5, v1
  s_lshl_b32 s19, s4, 3
  v_add_u32 v10, s19, v7
  v_lshl_add_u32 v11, v9, 5, v10
  v_lshlrev_b32 v11, 4, v11
  v_lshl_add_u32 v11, v8, 10, v11
  v_lshlrev_b32 v12, 10, v10
  v_lshl_add_u32 v12, v8, 4, v12
  v_lshl_add_u32 v12, v9, 3, v12
  s_lshl_b32 s19, s5, 6
  v_add_u32 v12, s19, v12
  v_lshlrev_b32 v13, 2, v10
  v_lshlrev_b32 v14, 4, v1
  s_mov_b32 s24, s6
  s_barrier
  s_mov_b32 s57, 0
  v_mov_b32 v20, 596992
L_o_wg:
  global_load_dword v23, v20, s[8:9] sc1
  s_waitcnt vmcnt(0)
  v_readfirstlane_b32 s58, v23
  s_nop 0
  s_cmp_ge_u32 s58, 4
  s_cbranch_scc1 L_o_wgd
  s_add_u32 s57, s57, 1
  s_cmp_gt_u32 s57, 300000
  s_cbranch_scc1 L_o_exit
  s_sleep 8
  s_branch L_o_wg
L_o_wgd:
  v_lshlrev_b32 v16, 4, v0
  v_add_u32 v16, 16384, v16
L_o_p1:
  s_lshr_b32 s26, s24, 2
  s_lshl_b32 s26, s26, 7
  s_add_u32 s26, s26, 593920
  v_mov_b32 v20, s26
  s_mov_b32 s57, 0
L_o_wh:
  global_load_dword v23, v20, s[8:9] sc1
  s_waitcnt vmcnt(0)
  v_readfirstlane_b32 s58, v23
  s_nop 0
  s_cmp_ge_u32 s58, 28
  s_cbranch_scc1 L_o_whd
  s_add_u32 s57, s57, 1
  s_cmp_gt_u32 s57, 600000
  s_cbranch_scc1 L_o_exit
  s_sleep 8
  s_branch L_o_wh
L_o_whd:
  s_mul_i32 s25, s24, 114688
  s_mul_i32 s26, s4, 28672
  s_add_u32 s25, s25, s26
  s_add_u32 s25, s25, 59768832
  s_add_u32 s30, s8, s25
  s_addc_u32 s31, s9, 0
  global_load_dwordx4 v[32:35], v14, s[30:31] offset:0 sc1
  global_load_dwordx4 v[36:39], v14, s[30:31] offset:1024 sc1
  global_load_dwordx4 v[40:43], v14, s[30:31] offset:2048 sc1
  global_load_dwordx4 v[44:47], v14, s[30:31] offset:3072 sc1
  s_add_u32 s30, s30, 4096
  s_addc_u32 s31, s31, 0
  global_load_dwordx4 v[48:51], v14, s[30:31] offset:0 sc1
  global_load_dwordx4 v[52:55], v14, s[30:31] offset:1024 sc1
  global_load_dwordx4 v[56:59], v14, s[30:31] offset:2048 sc1
  global_load_dwordx4 v[60:63], v14, s[30:31] offset:3072 sc1
  s_add_u32 s30, s30, 4096
  s_addc_u32 s31, s31, 0
  global_load_dwordx4 v[96:99], v14, s[30:31] offset:0 sc1
  global_load_dwordx4 v[100:103], v14, s[30:31] offset:1024 sc1
  global_load_dwordx4 v[104:107], v14, s[30:31] offset:2048 sc1
  global_load_dwordx4 v[108:111], v14, s[30:31] offset:3072 sc1
  s_add_u32 s30, s30, 4096
  s_addc_u32 s31, s31, 0
  global_load_dwordx4 v[112:115], v14, s[30:31] offset:0 sc1
  global_load_dwordx4 v[116:119], v14, s[30:31] offset:1024 sc1
  global_load_dwordx4 v[120:123], v14, s[30:31] offset:2048 sc1
  global_load_dwordx4 v[124:127], v14, s[30:31] offset:3072 sc1
  s_add_u32 s30, s30, 4096
  s_addc_u32 s31, s31, 0
  s_waitcnt vmcnt(15)
  v_mfma_f32_32x32x16_bf16 v[80:95], v[128:131], v[32:35], 0
  global_load_dwordx4 v[32:35], v14, s[30:31] offset:0 sc1
  s_waitcnt vmcnt(15)
  v_mfma_f32_32x32x16_bf16 v[80:95], v[132:135], v[36:39], v[80:95]
  global_load_dwordx4 v[36:39], v14, s[30:31] offset:1024 sc1
  s_waitcnt vmcnt(15)
  v_mfma_f32_32x32x16_bf16 v[80:95], v[136:139], v[40:43], v[80:95]
  global_load_dwordx4 v[40:43], v14, s[30:31] offset:2048 sc1
  s_waitcnt vmcnt(15)
  v_mfma_f32_32x32x16_bf16 v[80:95], v[140:143], v[44:47], v[80:95]
  global_load_dwordx4 v[44:47], v14, s[30:31] offset:3072 sc1
  s_add_u32 s30, s30, 4096
  s_addc_u32 s31, s31, 0
  s_waitcnt vmcnt(15)
  v_mfma_f32_32x32x16_bf16 v[80:95], v[144:147], v[48:51], v[80:95]
  global_load_dwordx4 v[48:51], v14, s[30:31] offset:0 sc1
  s_waitcnt vmcnt(15)
  v_mfma_f32_32x32x16_bf16 v[80:95], v[148:151], v[52:55], v[80:95]
  global_load_dwordx4 v[52:55], v14, s[30:31] offset:1024 sc1
  s_waitcnt vmcnt(15)
  v_mfma_f32_32x32x16_bf16 v[80:95], v[152:155], v[56:59], v[80:95]
  global_load_dwordx4 v[56:59], v14, s[30:31] offset:2048 sc1
  s_waitcnt vmcnt(15)
  v_mfma_f32_32x32x16_bf16 v[80:95], v[156:159], v[60:63], v[80:95]
  global_load_dwordx4 v[60:63], v14, s[30:31] offset:3072 sc1
  s_add_u32 s30, s30, 4096
  s_addc_u32 s31, s31, 0
  s_waitcnt vmcnt(15)
  v_mfma_f32_32x32x16_bf16 v[80:95], v[160:163], v[96:99], v[80:95]
  global_load_dwordx4 v[96:99], v14, s[30:31] offset:0 sc1
  s_waitcnt vmcnt(15)
  v_mfma_f32_32x32x16_bf16 v[80:95], v[164:167], v[100:103], v[80:95]
  global_load_dwordx4 v[100:103], v14, s[30:31] offset:1024 sc1
  s_waitcnt vmcnt(15)
  v_mfma_f32_32x32x16_bf16 v[80:95], v[168:171], v[104:107], v[80:95]
  global_load_dwordx4 v[104:107], v14, s[30:31] offset:2048 sc1
  s_waitcnt vmcnt(15)
  v_mfma_f32_32x32x16_bf16 v[80:95], v[172:175], v[108:111], v[80:95]
  global_load_dwordx4 v[108:111], v14, s[30:31] offset:3072 sc1
  s_add_u32 s30, s30, 4096
  s_addc_u32 s31, s31, 0
  s_waitcnt vmcnt(15)
  v_mfma_f32_32x32x16_bf16 v[80:95], v[176:179], v[112:115], v[80:95]
  s_waitcnt vmcnt(14)
  v_mfma_f32_32x32x16_bf16 v[80:95], v[180:183], v[116:119], v[80:95]
  s_waitcnt vmcnt(13)
  v_mfma_f32_32x32x16_bf16 v[80:95], v[184:187], v[120:123], v[80:95]
  s_waitcnt vmcnt(12)
  v_mfma_f32_32x32x16_bf16 v[80:95], v[188:191], v[124:127], v[80:95]
  s_waitcnt vmcnt(11)
  v_mfma_f32_32x32x16_bf16 v[80:95], v[192:195], v[32:35], v[80:95]
  s_waitcnt vmcnt(10)
  v_mfma_f32_32x32x16_bf16 v[80:95], v[196:199], v[36:39], v[80:95]
  s_waitcnt vmcnt(9)
  v_mfma_f32_32x32x16_bf16 v[80:95], v[200:203], v[40:43], v[80:95]
  s_waitcnt vmcnt(8)
  v_mfma_f32_32x32x16_bf16 v[80:95], v[204:207], v[44:47], v[80:95]
  s_waitcnt vmcnt(7)
  v_mfma_f32_32x32x16_bf16 v[80:95], v[208:211], v[48:51], v[80:95]
  s_waitcnt vmcnt(6)
  v_mfma_f32_32x32x16_bf16 v[80:95], v[212:215], v[52:55], v[80:95]
  s_waitcnt vmcnt(5)
  v_mfma_f32_32x32x16_bf16 v[80:95], v[216:219], v[56:59], v[80:95]
  s_waitcnt vmcnt(4)
  v_mfma_f32_32x32x16_bf16 v[80:95], v[220:223], v[60:63], v[80:95]
  s_waitcnt vmcnt(3)
  v_mfma_f32_32x32x16_bf16 v[80:95], v[224:227], v[96:99], v[80:95]
  s_waitcnt vmcnt(2)
  v_mfma_f32_32x32x16_bf16 v[80:95], v[228:231], v[100:103], v[80:95]
  s_waitcnt vmcnt(1)
  v_mfma_f32_32x32x16_bf16 v[80:95], v[232:235], v[104:107], v[80:95]
  s_waitcnt vmcnt(0)
  v_mfma_f32_32x32x16_bf16 v[80:95], v[236:239], v[108:111], v[80:95]
  s_nop 11
  ds_write_b128 v6, v[80:83] offset:0
  ds_write_b128 v6, v[84:87] offset:1024
  ds_write_b128 v6, v[88:91] offset:2048
  ds_write_b128 v6, v[92:95] offset:3072
  s_waitcnt lgkmcnt(0)
  s_barrier
  ds_read_b128 v[32:35], v11 offset:0
  ds_read_b128 v[36:39], v11 offset:4096
  ds_read_b128 v[40:43], v11 offset:8192
  ds_read_b128 v[44:47], v11 offset:12288
  s_waitcnt lgkmcnt(0)
  s_barrier
  v_pk_add_f32 v[32:33], v[32:33], v[36:37]
  v_pk_add_f32 v[40:41], v[40:41], v[44:45]
  v_pk_add_f32 v[34:35], v[34:35], v[38:39]
  v_pk_add_f32 v[42:43], v[42:43], v[46:47]
  v_pk_add_f32 v[32:33], v[32:33], v[40:41]
  v_pk_add_f32 v[34:35], v[34:35], v[42:43]
  ds_write_b128 v16, v[32:35]
  v_add_u32 v16, 4096, v16
  s_add_u32 s24, s24, s7
  s_cmp_lt_u32 s24, 64
  s_cbranch_scc1 L_o_p1
  s_mov_b32 s24, s6
  v_lshlrev_b32 v16, 4, v0
  v_add_u32 v16, 16384, v16
  s_waitcnt lgkmcnt(0)
L_o_seg:
  s_lshl_b32 s25, s24, 7
  s_add_u32 s25, s25, 89128960
  s_add_u32 s32, s8, s25
  s_addc_u32 s33, s9, 0
  global_load_dword v15, v13, s[32:33] sc1
  ds_read_b128 v[80:83], v16
  v_add_u32 v16, 4096, v16
  s_lshl_b32 s25, s24, 7
  s_add_u32 s25, s25, 606208
  v_mov_b32 v20, s25
  s_mov_b32 s57, 0
L_o_w:
  global_load_dword v23, v20, s[8:9] sc1
  s_waitcnt vmcnt(0)
  v_readfirstlane_b32 s58, v23
  s_nop 0
  s_cmp_ge_u32 s58, 32
  s_cbranch_scc1 L_o_wd
  s_add_u32 s57, s57, 1
  s_cmp_gt_u32 s57, 600000
  s_cbranch_scc1 L_o_exit
  s_nop 0
  s_branch L_o_w
L_o_wd:
  s_lshl_b32 s25, s24, 18
  s_lshl_b32 s26, s4, 16
  s_add_u32 s25, s25, s26
  s_add_u32 s25, s25, 68157440
  s_add_u32 s28, s8, s25
  s_addc_u32 s29, s9, 0
  global_load_dwordx4 v[128:131], v14, s[28:29] offset:0 sc1
  global_load_dwordx4 v[132:135], v14, s[28:29] offset:1024 sc1
  global_load_dwordx4 v[136:139], v14, s[28:29] offset:2048 sc1
  global_load_dwordx4 v[140:143], v14, s[28:29] offset:3072 sc1
  s_add_u32 s28, s28, 4096
  s_addc_u32 s29, s29, 0
  global_load_dwordx4 v[144:147], v14, s[28:29] offset:0 sc1
  global_load_dwordx4 v[148:151], v14, s[28:29] offset:1024 sc1
  global_load_dwordx4 v[152:155], v14, s[28:29] offset:2048 sc1
  global_load_dwordx4 v[156:159], v14, s[28:29] offset:3072 sc1
  s_add_u32 s28, s28, 4096
  s_addc_u32 s29, s29, 0
  global_load_dwordx4 v[160:163], v14, s[28:29] offset:0 sc1
  global_load_dwordx4 v[164:167], v14, s[28:29] offset:1024 sc1
  global_load_dwordx4 v[168:171], v14, s[28:29] offset:2048 sc1
  global_load_dwordx4 v[172:175], v14, s[28:29] offset:3072 sc1
  s_add_u32 s28, s28, 4096
  s_addc_u32 s29, s29, 0
  global_load_dwordx4 v[176:179], v14, s[28:29] offset:0 sc1
  global_load_dwordx4 v[180:183], v14, s[28:29] offset:1024 sc1
  global_load_dwordx4 v[184:187], v14, s[28:29] offset:2048 sc1
  global_load_dwordx4 v[188:191], v14, s[28:29] offset:3072 sc1
  s_add_u32 s28, s28, 4096
  s_addc_u32 s29, s29, 0
  global_load_dwordx4 v[192:195], v14, s[28:29] offset:0 sc1
  global_load_dwordx4 v[196:199], v14, s[28:29] offset:1024 sc1
  global_load_dwordx4 v[200:203], v14, s[28:29] offset:2048 sc1
  global_load_dwordx4 v[204:207], v14, s[28:29] offset:3072 sc1
  s_add_u32 s28, s28, 4096
  s_addc_u32 s29, s29, 0
  global_load_dwordx4 v[208:211], v14, s[28:29] offset:0 sc1
  global_load_dwordx4 v[212:215], v14, s[28:29] offset:1024 sc1
  global_load_dwordx4 v[216:219], v14, s[28:29] offset:2048 sc1
  global_load_dwordx4 v[220:223], v14, s[28:29] offset:3072 sc1
  s_add_u32 s28, s28, 4096
  s_addc_u32 s29, s29, 0
  global_load_dwordx4 v[224:227], v14, s[28:29] offset:0 sc1
  global_load_dwordx4 v[228:231], v14, s[28:29] offset:1024 sc1
  global_load_dwordx4 v[232:235], v14, s[28:29] offset:2048 sc1
  global_load_dwordx4 v[236:239], v14, s[28:29] offset:3072 sc1
  s_add_u32 s28, s28, 4096
  s_addc_u32 s29, s29, 0
  global_load_dwordx4 v[240:243], v14, s[28:29] offset:0 sc1
  global_load_dwordx4 v[244:247], v14, s[28:29] offset:1024 sc1
  global_load_dwordx4 v[248:251], v14, s[28:29] offset:2048 sc1
  global_load_dwordx4 v[252:255], v14, s[28:29] offset:3072 sc1
  s_add_u32 s28, s28, 4096
  s_addc_u32 s29, s29, 0
  global_load_dwordx4 v[32:35], v14, s[28:29] offset:0 sc1
  global_load_dwordx4 v[36:39], v14, s[28:29] offset:1024 sc1
  global_load_dwordx4 v[40:43], v14, s[28:29] offset:2048 sc1
  global_load_dwordx4 v[44:47], v14, s[28:29] offset:3072 sc1
  s_add_u32 s28, s28, 4096
  s_addc_u32 s29, s29, 0
  global_load_dwordx4 v[48:51], v14, s[28:29] offset:0 sc1
  global_load_dwordx4 v[52:55], v14, s[28:29] offset:1024 sc1
  global_load_dwordx4 v[56:59], v14, s[28:29] offset:2048 sc1
  global_load_dwordx4 v[60:63], v14, s[28:29] offset:3072 sc1
  s_add_u32 s28, s28, 4096
  s_addc_u32 s29, s29, 0
  global_load_dwordx4 v[96:99], v14, s[28:29] offset:0 sc1
  global_load_dwordx4 v[100:103], v14, s[28:29] offset:1024 sc1
  global_load_dwordx4 v[104:107], v14, s[28:29] offset:2048 sc1
  global_load_dwordx4 v[108:111], v14, s[28:29] offset:3072 sc1
  s_add_u32 s28, s28, 4096
  s_addc_u32 s29, s29, 0
  global_load_dwordx4 v[112:115], v14, s[28:29] offset:0 sc1
  global_load_dwordx4 v[116:119], v14, s[28:29] offset:1024 sc1
  global_load_dwordx4 v[120:123], v14, s[28:29] offset:2048 sc1
  global_load_dwordx4 v[124:127], v14, s[28:29] offset:3072 sc1
  s_add_u32 s28, s28, 4096
  s_addc_u32 s29, s29, 0
  s_waitcnt vmcnt(47)
  v_mfma_f32_32x32x16_bf16 v[64:79], a[0:3], v[128:131], 0
  global_load_dwordx4 v[128:131], v14, s[28:29] offset:0 sc1
  s_waitcnt vmcnt(47)
  v_mfma_f32_32x32x16_bf16 v[64:79], a[4:7], v[132:135], v[64:79]
  global_load_dwordx4 v[132:135], v14, s[28:29] offset:1024 sc1
  s_waitcnt vmcnt(47)
  v_mfma_f32_32x32x16_bf16 v[64:79], a[8:11], v[136:139], v[64:79]
  global_load_dwordx4 v[136:139], v14, s[28:29] offset:2048 sc1
  s_waitcnt vmcnt(47)
  v_mfma_f32_32x32x16_bf16 v[64:79], a[12:15], v[140:143], v[64:79]
  global_load_dwordx4 v[140:143], v14, s[28:29] offset:3072 sc1
  s_add_u32 s28, s28, 4096
  s_addc_u32 s29, s29, 0
  s_waitcnt vmcnt(47)
  v_mfma_f32_32x32x16_bf16 v[64:79], a[16:19], v[144:147], v[64:79]
  global_load_dwordx4 v[144:147], v14, s[28:29] offset:0 sc1
  s_waitcnt vmcnt(47)
  v_mfma_f32_32x32x16_bf16 v[64:79], a[20:23], v[148:151], v[64:79]
  global_load_dwordx4 v[148:151], v14, s[28:29] offset:1024 sc1
  s_waitcnt vmcnt(47)
  v_mfma_f32_32x32x16_bf16 v[64:79], a[24:27], v[152:155], v[64:79]
  global_load_dwordx4 v[152:155], v14, s[28:29] offset:2048 sc1
  s_waitcnt vmcnt(47)
  v_mfma_f32_32x32x16_bf16 v[64:79], a[28:31], v[156:159], v[64:79]
  global_load_dwordx4 v[156:159], v14, s[28:29] offset:3072 sc1
  s_add_u32 s28, s28, 4096
  s_addc_u32 s29, s29, 0
  s_waitcnt vmcnt(47)
  v_mfma_f32_32x32x16_bf16 v[64:79], a[32:35], v[160:163], v[64:79]
  global_load_dwordx4 v[160:163], v14, s[28:29] offset:0 sc1
  s_waitcnt vmcnt(47)
  v_mfma_f32_32x32x16_bf16 v[64:79], a[36:39], v[164:167], v[64:79]
  global_load_dwordx4 v[164:167], v14, s[28:29] offset:1024 sc1
  s_waitcnt vmcnt(47)
  v_mfma_f32_32x32x16_bf16 v[64:79], a[40:43], v[168:171], v[64:79]
  global_load_dwordx4 v[168:171], v14, s[28:29] offset:2048 sc1
  s_waitcnt vmcnt(47)
  v_mfma_f32_32x32x16_bf16 v[64:79], a[44:47], v[172:175], v[64:79]
  global_load_dwordx4 v[172:175], v14, s[28:29] offset:3072 sc1
  s_add_u32 s28, s28, 4096
  s_addc_u32 s29, s29, 0
  s_waitcnt vmcnt(47)
  v_mfma_f32_32x32x16_bf16 v[64:79], a[48:51], v[176:179], v[64:79]
  global_load_dwordx4 v[176:179], v14, s[28:29] offset:0 sc1
  s_waitcnt vmcnt(47)
  v_mfma_f32_32x32x16_bf16 v[64:79], a[52:55], v[180:183], v[64:79]
  global_load_dwordx4 v[180:183], v14, s[28:29] offset:1024 sc1
  s_waitcnt vmcnt(47)
  v_mfma_f32_32x32x16_bf16 v[64:79], a[56:59], v[184:187], v[64:79]
  global_load_dwordx4 v[184:187], v14, s[28:29] offset:2048 sc1
  s_waitcnt vmcnt(47)
  v_mfma_f32_32x32x16_bf16 v[64:79], a[60:63], v[188:191], v[64:79]
  global_load_dwordx4 v[188:191], v14, s[28:29] offset:3072 sc1
  s_add_u32 s28, s28, 4096
  s_addc_u32 s29, s29, 0
  s_waitcnt vmcnt(47)
  v_mfma_f32_32x32x16_bf16 v[64:79], a[64:67], v[192:195], v[64:79]
  s_waitcnt vmcnt(46)
  v_mfma_f32_32x32x16_bf16 v[64:79], a[68:71], v[196:199], v[64:79]
  s_waitcnt vmcnt(45)
  v_mfma_f32_32x32x16_bf16 v[64:79], a[72:75], v[200:203], v[64:79]
  s_waitcnt vmcnt(44)
  v_mfma_f32_32x32x16_bf16 v[64:79], a[76:79], v[204:207], v[64:79]
  s_waitcnt vmcnt(43)
  v_mfma_f32_32x32x16_bf16 v[64:79], a[80:83], v[208:211], v[64:79]
  s_waitcnt vmcnt(42)
  v_mfma_f32_32x32x16_bf16 v[64:79], a[84:87], v[212:215], v[64:79]
  s_waitcnt vmcnt(41)
  v_mfma_f32_32x32x16_bf16 v[64:79], a[88:91], v[216:219], v[64:79]
  s_waitcnt vmcnt(40)
  v_mfma_f32_32x32x16_bf16 v[64:79], a[92:95], v[220:223], v[64:79]
  s_waitcnt vmcnt(39)
  v_mfma_f32_32x32x16_bf16 v[64:79], a[96:99], v[224:227], v[64:79]
  s_waitcnt vmcnt(38)
  v_mfma_f32_32x32x16_bf16 v[64:79], a[100:103], v[228:231], v[64:79]
  s_waitcnt vmcnt(37)
  v_mfma_f32_32x32x16_bf16 v[64:79], a[104:107], v[232:235], v[64:79]
  s_waitcnt vmcnt(36)
  v_mfma_f32_32x32x16_bf16 v[64:79], a[108:111], v[236:239], v[64:79]
  s_waitcnt vmcnt(35)
  v_mfma_f32_32x32x16_bf16 v[64:79], a[112:115], v[240:243], v[64:79]
  s_waitcnt vmcnt(34)
  v_mfma_f32_32x32x16_bf16 v[64:79], a[116:119], v[244:247], v[64:79]
  s_waitcnt vmcnt(33)
  v_mfma_f32_32x32x16_bf16 v[64:79], a[120:123], v[248:251], v[64:79]
  s_waitcnt vmcnt(32)
  v_mfma_f32_32x32x16_bf16 v[64:79], a[124:127], v[252:255], v[64:79]
  s_waitcnt vmcnt(31)
  v_mfma_f32_32x32x16_bf16 v[64:79], a[128:131], v[32:35], v[64:79]
  s_waitcnt vmcnt(30)
  v_mfma_f32_32x32x16_bf16 v[64:79], a[132:135], v[36:39], v[64:79]
  s_waitcnt vmcnt(29)
  v_mfma_f32_32x32x16_bf16 v[64:79], a[136:139], v[40:43], v[64:79]
  s_waitcnt vmcnt(28)
  v_mfma_f32_32x32x16_bf16 v[64:79], a[140:143], v[44:47], v[64:79]
  s_waitcnt vmcnt(27)
  v_mfma_f32_32x32x16_bf16 v[64:79], a[144:147], v[48:51], v[64:79]
  s_waitcnt vmcnt(26)
  v_mfma_f32_32x32x16_bf16 v[64:79], a[148:151], v[52:55], v[64:79]
  s_waitcnt vmcnt(25)
  v_mfma_f32_32x32x16_bf16 v[64:79], a[152:155], v[56:59], v[64:79]
  s_waitcnt vmcnt(24)
  v_mfma_f32_32x32x16_bf16 v[64:79], a[156:159], v[60:63], v[64:79]
  s_waitcnt vmcnt(23)
  v_mfma_f32_32x32x16_bf16 v[64:79], a[160:163], v[96:99], v[64:79]
  s_waitcnt vmcnt(22)
  v_mfma_f32_32x32x16_bf16 v[64:79], a[164:167], v[100:103], v[64:79]
  s_waitcnt vmcnt(21)
  v_mfma_f32_32x32x16_bf16 v[64:79], a[168:171], v[104:107], v[64:79]
  s_waitcnt vmcnt(20)
  v_mfma_f32_32x32x16_bf16 v[64:79], a[172:175], v[108:111], v[64:79]
  s_waitcnt vmcnt(19)
  v_mfma_f32_32x32x16_bf16 v[64:79], a[176:179], v[112:115], v[64:79]
  s_waitcnt vmcnt(18)
  v_mfma_f32_32x32x16_bf16 v[64:79], a[180:183], v[116:119], v[64:79]
  s_waitcnt vmcnt(17)
  v_mfma_f32_32x32x16_bf16 v[64:79], a[184:187], v[120:123], v[64:79]
  s_waitcnt vmcnt(16)
  v_mfma_f32_32x32x16_bf16 v[64:79], a[188:191], v[124:127], v[64:79]
  s_waitcnt vmcnt(15)
  v_mfma_f32_32x32x16_bf16 v[64:79], a[192:195], v[128:131], v[64:79]
  s_waitcnt vmcnt(14)
  v_mfma_f32_32x32x16_bf16 v[64:79], a[196:199], v[132:135], v[64:79]
  s_waitcnt vmcnt(13)
  v_mfma_f32_32x32x16_bf16 v[64:79], a[200:203], v[136:139], v[64:79]
  s_waitcnt vmcnt(12)
  v_mfma_f32_32x32x16_bf16 v[64:79], a[204:207], v[140:143], v[64:79]
  s_waitcnt vmcnt(11)
  v_mfma_f32_32x32x16_bf16 v[64:79], a[208:211], v[144:147], v[64:79]
  s_waitcnt vmcnt(10)
  v_mfma_f32_32x32x16_bf16 v[64:79], a[212:215], v[148:151], v[64:79]
  s_waitcnt vmcnt(9)
  v_mfma_f32_32x32x16_bf16 v[64:79], a[216:219], v[152:155], v[64:79]
  s_waitcnt vmcnt(8)
  v_mfma_f32_32x32x16_bf16 v[64:79], a[220:223], v[156:159], v[64:79]
  s_waitcnt vmcnt(7)
  v_mfma_f32_32x32x16_bf16 v[64:79], a[224:227], v[160:163], v[64:79]
  s_waitcnt vmcnt(6)
  v_mfma_f32_32x32x16_bf16 v[64:79], a[228:231], v[164:167], v[64:79]
  s_waitcnt vmcnt(5)
  v_mfma_f32_32x32x16_bf16 v[64:79], a[232:235], v[168:171], v[64:79]
  s_waitcnt vmcnt(4)
  v_mfma_f32_32x32x16_bf16 v[64:79], a[236:239], v[172:175], v[64:79]
  s_waitcnt vmcnt(3)
  v_mfma_f32_32x32x16_bf16 v[64:79], a[240:243], v[176:179], v[64:79]
  s_waitcnt vmcnt(2)
  v_mfma_f32_32x32x16_bf16 v[64:79], a[244:247], v[180:183], v[64:79]
  s_waitcnt vmcnt(1)
  v_mfma_f32_32x32x16_bf16 v[64:79], a[248:251], v[184:187], v[64:79]
  s_waitcnt vmcnt(0)
  v_mfma_f32_32x32x16_bf16 v[64:79], a[252:255], v[188:191], v[64:79]
  s_nop 11
  ds_write_b128 v6, v[64:67] offset:0
  ds_write_b128 v6, v[68:71] offset:1024
  ds_write_b128 v6, v[72:75] offset:2048
  ds_write_b128 v6, v[76:79] offset:3072
  s_waitcnt lgkmcnt(0)
  s_barrier
  ds_read_b128 v[32:35], v11 offset:0
  ds_read_b128 v[36:39], v11 offset:4096
  ds_read_b128 v[40:43], v11 offset:8192
  ds_read_b128 v[44:47], v11 offset:12288
  s_waitcnt lgkmcnt(0)
  s_barrier
  v_pk_add_f32 v[32:33], v[32:33], v[36:37]
  v_pk_add_f32 v[40:41], v[40:41], v[44:45]
  v_pk_add_f32 v[34:35], v[34:35], v[38:39]
  v_pk_add_f32 v[42:43], v[42:43], v[46:47]
  v_pk_add_f32 v[32:33], v[32:33], v[40:41]
  v_pk_add_f32 v[34:35], v[34:35], v[42:43]
  v_sub_f32 v32, v32, v80
  v_fma_f32 v32, v15, v32, v80
  v_sub_f32 v33, v33, v81
  v_fma_f32 v33, v15, v33, v81
  v_sub_f32 v34, v34, v82
  v_fma_f32 v34, v15, v34, v82
  v_sub_f32 v35, v35, v83
  v_fma_f32 v35, v15, v35, v83
  v_cvt_pk_bf16_f32 v40, v32, v33
  v_cvt_pk_bf16_f32 v41, v34, v35
  s_lshl_b32 s25, s24, 15
  s_add_u32 s34, s16, s25
  s_addc_u32 s35, s17, 0
  global_store_dwordx2 v12, v[40:41], s[34:35]
  s_add_u32 s24, s24, s7
  s_cmp_lt_u32 s24, 64
  s_cbranch_scc1 L_o_seg
L_o_exit:
  s_branch L_end
L_isattn_lo:
  s_sub_u32 s12, s98, 1
  s_lshl_b32 s12, s12, 4
  s_add_u32 s12, s12, s99
  s_sub_u32 s12, s12, 16
  s_branch L_isattn
L_isattn_hi:
  s_sub_u32 s12, s98, 5
  s_lshl_b32 s12, s12, 5
  s_add_u32 s12, s12, s99
  s_add_u32 s12, s12, 64
L_isattn:
  s_lshl_b32 s50, s12, 2
  s_add_u32 s50, s50, s4
  s_lshr_b32 s51, s50, 5
  s_and_b32 s50, s50, 31
  s_mov_b32 s52, 20
  v_and_b32 v1, 63, v0
  v_and_b32 v2, 15, v1
  v_lshrrev_b32 v3, 4, v1
  v_lshlrev_b32 v4, 4, v1
  v_lshlrev_b32 v5, 7, v2
  v_lshl_add_u32 v5, v3, 4, v5
  v_lshlrev_b32 v6, 3, v1
  v_lshlrev_b32 v7, 9, v3
  v_lshl_add_u32 v7, v2, 4, v7
  v_add_u32 v8, 0x1000, v7
  v_add_u32 v9, 0x1000, v4
  v_add_u32 v10, 0x1000, v5
  v_and_b32 v11, 7, v2
  v_lshrrev_b32 v12, 2, v11
  v_and_b32 v13, 1, v3
  v_cmp_eq_u32 vcc, v12, v13
  v_and_b32 v11, 3, v11
  v_mov_b32 v14, 0x3f80
  v_mov_b32 v15, 0x3f800000
  v_mov_b32 v16, 0
  v_mov_b32 v17, 0
  v_cmp_eq_u32 s[60:61], 0, v11
  s_nop 1
  v_cndmask_b32 v16, v16, v14, s[60:61]
  v_cmp_eq_u32 s[60:61], 1, v11
  s_nop 1
  v_cndmask_b32 v16, v16, v15, s[60:61]
  v_cmp_eq_u32 s[60:61], 2, v11
  s_nop 1
  v_cndmask_b32 v17, v17, v14, s[60:61]
  v_cmp_eq_u32 s[60:61], 3, v11
  s_nop 1
  v_cndmask_b32 v17, v17, v15, s[60:61]
  v_cndmask_b32 v16, 0, v16, vcc
  v_cndmask_b32 v17, 0, v17, vcc
  s_mov_b32 s34, -1
  s_mov_b32 s35, 0
  s_mov_b32 s36, 0
  s_mov_b32 s37, -1
  v_cndmask_b32 v204, 0, v16, s[34:35]
  v_cndmask_b32 v205, 0, v17, s[34:35]
  v_cndmask_b32 v206, 0, v16, s[36:37]
  v_cndmask_b32 v207, 0, v17, s[36:37]
  v_mov_b32 v208, 0x3f803f80
  v_mov_b32 v209, 0x3f803f80
  v_mov_b32 v210, 0x3f803f80
  v_mov_b32 v211, 0x3f803f80
  v_lshlrev_b32 v11, 3, v3
  v_sub_u32 v11, v2, v11
  v_add_u32 v12, 16, v11
  s_mov_b32 s32, 1040356334
  s_mov_b32 s33, 1040356334
  v_mov_b32 v18, 0xf149f2ca
  v_cmp_le_i32 s[64:65], 0, v11
  v_cmp_le_i32 s[66:67], 1, v11
  v_cmp_le_i32 s[68:69], 2, v11
  v_cmp_le_i32 s[70:71], 3, v11
  v_cmp_le_i32 s[72:73], 4, v11
  v_cmp_le_i32 s[74:75], 5, v11
  v_cmp_le_i32 s[76:77], 6, v11
  v_cmp_le_i32 s[78:79], 7, v11
  v_cmp_le_i32 s[80:81], 0, v12
  v_cmp_le_i32 s[82:83], 1, v12
  v_cmp_le_i32 s[84:85], 2, v12
  v_cmp_le_i32 s[86:87], 3, v12
  v_cmp_le_i32 s[88:89], 4, v12
  v_cmp_le_i32 s[90:91], 5, v12
  v_cmp_le_i32 s[92:93], 6, v12
  v_cmp_le_i32 s[94:95], 7, v12
  s_mov_b32 s53, s51
L_a_item:
  s_lshr_b32 s55, s53, 2
  s_lshl_b32 s55, s55, 7
  s_add_u32 s56, s55, 591872
  s_add_u32 s55, s55, 589824
  v_mov_b32 v21, s55
  v_mov_b32 v22, s56
  s_mov_b32 s57, 0
L_a_wait:
  global_load_dword v24, v21, s[8:9] sc1
  global_load_dword v25, v22, s[8:9] sc1
  s_waitcnt vmcnt(0)
  v_readfirstlane_b32 s59, v24
  v_readfirstlane_b32 s62, v25
  s_cmp_ge_u32 s59, 128
  s_cselect_b32 s59, 1, 0
  s_cmp_ge_u32 s62, 64
  s_cselect_b32 s59, s59, 0
  s_cmp_eq_u32 s59, 1
  s_cbranch_scc1 L_a_go
  s_add_u32 s57, s57, 1
  s_cmp_gt_u32 s57, 300000
  s_cbranch_scc1 L_a_exit
  s_sleep 8
  s_branch L_a_wait
L_a_go:
  s_lshl_b32 s54, s53, 5
  s_add_u32 s54, s54, s50
  s_lshl_b32 s55, s54, 13
  s_add_u32 s40, s8, s55
  s_addc_u32 s41, s9, 0
  s_add_u32 s42, s40, 34603008
  s_addc_u32 s43, s41, 0
  s_add_u32 s44, s40, 17825792
  s_addc_u32 s45, s41, 0
  s_add_u32 s40, s40, 1048576
  s_addc_u32 s41, s41, 0
  s_lshl_b32 s55, s54, 11
  s_add_u32 s46, s8, s55
  s_addc_u32 s47, s9, 0
  s_add_u32 s48, s46, 55574528
  s_addc_u32 s49, s47, 0
  s_add_u32 s46, s46, 51380224
  s_addc_u32 s47, s47, 0
  global_load_dwordx4 v[32:35], v4, s[42:43] offset:0 sc1
  global_load_dwordx4 v[36:39], v4, s[42:43] offset:1024 sc1
  global_load_dwordx4 v[40:43], v4, s[42:43] offset:2048 sc1
  global_load_dwordx4 v[44:47], v4, s[42:43] offset:3072 sc1
  global_load_dwordx4 v[48:51], v9, s[42:43] offset:0 sc1
  global_load_dwordx4 v[52:55], v9, s[42:43] offset:1024 sc1
  global_load_dwordx4 v[56:59], v9, s[42:43] offset:2048 sc1
  global_load_dwordx4 v[60:63], v9, s[42:43] offset:3072 sc1
  global_load_dwordx4 v[64:67], v4, s[40:41] offset:0 sc1
  global_load_dwordx4 v[68:71], v4, s[40:41] offset:1024 sc1
  global_load_dwordx4 v[72:75], v4, s[40:41] offset:2048 sc1
  global_load_dwordx4 v[76:79], v4, s[40:41] offset:3072 sc1
  global_load_dwordx4 v[80:83], v9, s[40:41] offset:0 sc1
  global_load_dwordx4 v[84:87], v9, s[40:41] offset:1024 sc1
  global_load_dwordx4 v[88:91], v9, s[40:41] offset:2048 sc1
  global_load_dwordx4 v[92:95], v9, s[40:41] offset:3072 sc1
  global_load_dwordx4 v[112:115], v5, s[44:45] offset:0 sc1
  global_load_dwordx4 v[116:119], v5, s[44:45] offset:64 sc1
  global_load_dwordx4 v[120:123], v5, s[44:45] offset:2048 sc1
  global_load_dwordx4 v[124:127], v5, s[44:45] offset:2112 sc1
  global_load_dwordx4 v[128:131], v10, s[44:45] offset:0 sc1
  global_load_dwordx4 v[132:135], v10, s[44:45] offset:64 sc1
  global_load_dwordx4 v[136:139], v10, s[44:45] offset:2048 sc1
  global_load_dwordx4 v[140:143], v10, s[44:45] offset:2112 sc1
  s_waitcnt vmcnt(8)
  v_mfma_f32_16x16x32_bf16 v[160:163], v[64:67], v[32:35], 0
  v_mfma_f32_16x16x32_bf16 v[160:163], v[68:71], v[36:39], v[160:163]
  v_mfma_f32_16x16x32_bf16 v[160:163], v[72:75], v[40:43], v[160:163]
  v_mfma_f32_16x16x32_bf16 v[160:163], v[76:79], v[44:47], v[160:163]
  v_mfma_f32_16x16x32_bf16 v[164:167], v[80:83], v[32:35], 0
  v_mfma_f32_16x16x32_bf16 v[164:167], v[84:87], v[36:39], v[164:167]
  v_mfma_f32_16x16x32_bf16 v[164:167], v[88:91], v[40:43], v[164:167]
  v_mfma_f32_16x16x32_bf16 v[164:167], v[92:95], v[44:47], v[164:167]
  v_mfma_f32_16x16x32_bf16 v[172:175], v[64:67], v[48:51], 0
  v_mfma_f32_16x16x32_bf16 v[172:175], v[68:71], v[52:55], v[172:175]
  v_mfma_f32_16x16x32_bf16 v[172:175], v[72:75], v[56:59], v[172:175]
  v_mfma_f32_16x16x32_bf16 v[172:175], v[76:79], v[60:63], v[172:175]
  v_mfma_f32_16x16x32_bf16 v[176:179], v[80:83], v[48:51], 0
  v_mfma_f32_16x16x32_bf16 v[176:179], v[84:87], v[52:55], v[176:179]
  v_mfma_f32_16x16x32_bf16 v[176:179], v[88:91], v[56:59], v[176:179]
  v_mfma_f32_16x16x32_bf16 v[176:179], v[92:95], v[60:63], v[176:179]
  v_cndmask_b32 v160, v18, v160, s[64:65]
  v_cndmask_b32 v161, v18, v161, s[66:67]
  v_cndmask_b32 v162, v18, v162, s[68:69]
  v_cndmask_b32 v163, v18, v163, s[70:71]
  v_cndmask_b32 v164, v18, v164, s[72:73]
  v_cndmask_b32 v165, v18, v165, s[74:75]
  v_cndmask_b32 v166, v18, v166, s[76:77]
  v_cndmask_b32 v167, v18, v167, s[78:79]
  v_cndmask_b32 v172, v18, v172, s[80:81]
  v_cndmask_b32 v173, v18, v173, s[82:83]
  v_cndmask_b32 v174, v18, v174, s[84:85]
  v_cndmask_b32 v175, v18, v175, s[86:87]
  v_cndmask_b32 v176, v18, v176, s[88:89]
  v_cndmask_b32 v177, v18, v177, s[90:91]
  v_cndmask_b32 v178, v18, v178, s[92:93]
  v_cndmask_b32 v179, v18, v179, s[94:95]
  s_lshl_b32 s54, s50, 7
  s_add_u32 s54, s54, 598016
  v_mov_b32 v20, s54
  s_mov_b32 s57, 0
L_a_wait2:
  global_load_dword v23, v20, s[8:9] sc1
  s_waitcnt vmcnt(0)
  v_readfirstlane_b32 s58, v23
  s_nop 0
  s_cmp_gt_u32 s58, s53
  s_cbranch_scc1 L_a_go2
  s_add_u32 s57, s57, 1
  s_cmp_gt_u32 s57, 600000
  s_cbranch_scc1 L_a_exit
  s_sub_u32 s59, s53, s58
  s_cmp_gt_u32 s59, 1
  s_cbranch_scc0 L_a_wait2
  s_sleep 16
  s_branch L_a_wait2
L_a_go2:
  global_load_dwordx2 v[144:145], v6, s[46:47] offset:0 sc1
  global_load_dwordx2 v[146:147], v6, s[46:47] offset:512 sc1
  global_load_dwordx2 v[148:149], v6, s[46:47] offset:1024 sc1
  global_load_dwordx2 v[150:151], v6, s[46:47] offset:1536 sc1
  global_load_dwordx2 v[152:153], v6, s[48:49] offset:0 sc1
  global_load_dwordx2 v[154:155], v6, s[48:49] offset:512 sc1
  global_load_dwordx2 v[156:157], v6, s[48:49] offset:1024 sc1
  global_load_dwordx2 v[158:159], v6, s[48:49] offset:1536 sc1
  s_waitcnt vmcnt(4)
  v_mfma_f32_16x16x16_bf16 v[192:195], v[144:145], v[204:205], 0
  v_mfma_f32_16x16x16_bf16 v[196:199], v[144:145], v[206:207], 0
  v_mfma_f32_16x16x16_bf16 v[216:219], v[146:147], v[204:205], 0
  v_mfma_f32_16x16x16_bf16 v[220:223], v[146:147], v[206:207], 0
  v_cvt_pk_bf16_f32 v96, v192, v196
  v_cvt_pk_bf16_f32 v97, v193, v197
  v_cvt_pk_bf16_f32 v98, v194, v198
  v_cvt_pk_bf16_f32 v99, v195, v199
  v_mfma_f32_16x16x16_bf16 v[192:195], v[148:149], v[204:205], 0
  v_mfma_f32_16x16x16_bf16 v[196:199], v[148:149], v[206:207], 0
  v_cvt_pk_bf16_f32 v100, v216, v220
  v_cvt_pk_bf16_f32 v101, v217, v221
  v_cvt_pk_bf16_f32 v102, v218, v222
  v_cvt_pk_bf16_f32 v103, v219, v223
  v_mfma_f32_16x16x16_bf16 v[216:219], v[150:151], v[204:205], 0
  v_mfma_f32_16x16x16_bf16 v[220:223], v[150:151], v[206:207], 0
  v_cvt_pk_bf16_f32 v104, v192, v196
  v_cvt_pk_bf16_f32 v105, v193, v197
  v_cvt_pk_bf16_f32 v106, v194, v198
  v_cvt_pk_bf16_f32 v107, v195, v199
  s_nop 3
  v_cvt_pk_bf16_f32 v108, v216, v220
  v_cvt_pk_bf16_f32 v109, v217, v221
  v_cvt_pk_bf16_f32 v110, v218, v222
  v_cvt_pk_bf16_f32 v111, v219, v223
  v_mfma_f32_16x16x32_bf16 v[168:171], v[96:99], v[32:35], 0
  v_mfma_f32_16x16x32_bf16 v[180:183], v[96:99], v[48:51], 0
  v_mfma_f32_16x16x32_bf16 v[168:171], v[100:103], v[36:39], v[168:171]
  v_mfma_f32_16x16x32_bf16 v[180:183], v[100:103], v[52:55], v[180:183]
  v_mfma_f32_16x16x32_bf16 v[168:171], v[104:107], v[40:43], v[168:171]
  v_mfma_f32_16x16x32_bf16 v[180:183], v[104:107], v[56:59], v[180:183]
  v_mfma_f32_16x16x32_bf16 v[168:171], v[108:111], v[44:47], v[168:171]
  v_mfma_f32_16x16x32_bf16 v[180:183], v[108:111], v[60:63], v[180:183]
  s_waitcnt vmcnt(0)
  s_lshl_b32 s55, s53, 18
  s_lshl_b32 s56, s50, 13
  s_add_u32 s55, s55, s56
  s_add_u32 s55, s55, 68157440
  s_add_u32 s40, s8, s55
  s_addc_u32 s41, s9, 0
  v_max3_f32 v213, v168, v169, v170
  v_max3_f32 v212, v160, v161, v162
  v_max3_f32 v213, v213, v171, v163
  v_max3_f32 v212, v212, v164, v165
  v_max3_f32 v213, v213, v166, v167
  v_max_f32 v212, v212, v213
  v_mov_b32 v213, v212
  s_nop 1
  v_permlane32_swap_b32 v212, v213
  v_max_f32 v212, v212, v213
  v_mov_b32 v213, v212
  s_nop 1
  v_permlane16_swap_b32 v212, v213
  v_max_f32 v212, v212, v213
  v_mul_f32 v214, s32, v212
  v_pk_fma_f32 v[160:161], v[160:161], s[32:33], v[214:215] op_sel_hi:[1,1,0] neg_lo:[0,0,1] neg_hi:[0,0,1]
  v_pk_fma_f32 v[162:163], v[162:163], s[32:33], v[214:215] op_sel_hi:[1,1,0] neg_lo:[0,0,1] neg_hi:[0,0,1]
  v_pk_fma_f32 v[164:165], v[164:165], s[32:33], v[214:215] op_sel_hi:[1,1,0] neg_lo:[0,0,1] neg_hi:[0,0,1]
  v_pk_fma_f32 v[166:167], v[166:167], s[32:33], v[214:215] op_sel_hi:[1,1,0] neg_lo:[0,0,1] neg_hi:[0,0,1]
  v_pk_fma_f32 v[168:169], v[168:169], s[32:33], v[214:215] op_sel_hi:[1,1,0] neg_lo:[0,0,1] neg_hi:[0,0,1]
  v_pk_fma_f32 v[170:171], v[170:171], s[32:33], v[214:215] op_sel_hi:[1,1,0] neg_lo:[0,0,1] neg_hi:[0,0,1]
  v_exp_f32 v160, v160
  v_exp_f32 v161, v161
  v_exp_f32 v162, v162
  v_exp_f32 v163, v163
  v_exp_f32 v164, v164
  v_exp_f32 v165, v165
  v_exp_f32 v166, v166
  v_exp_f32 v167, v167
  v_exp_f32 v168, v168
  v_exp_f32 v169, v169
  v_exp_f32 v170, v170
  v_exp_f32 v171, v171
  v_cvt_pk_bf16_f32 v184, v160, v161
  v_cvt_pk_bf16_f32 v185, v162, v163
  v_cvt_pk_bf16_f32 v186, v164, v165
  v_cvt_pk_bf16_f32 v187, v166, v167
  v_cvt_pk_bf16_f32 v190, v168, v169
  v_cvt_pk_bf16_f32 v191, v170, v171
  v_cndmask_b32 v188, 0, v190, s[34:35]
  v_cndmask_b32 v189, 0, v191, s[34:35]
  v_cndmask_b32 v190, 0, v190, s[36:37]
  v_cndmask_b32 v191, 0, v191, s[36:37]
  v_mfma_f32_16x16x32_bf16 v[200:203], v[208:211], v[184:187], 0
  s_nop 5
  v_mfma_f32_16x16x16_bf16 v[200:203], v[208:209], v[188:189], v[200:203]
  v_mfma_f32_16x16x32_bf16 v[192:195], v[112:115], v[184:187], 0
  v_mfma_f32_16x16x32_bf16 v[196:199], v[116:119], v[184:187], 0
  s_nop 1
  v_mfma_f32_16x16x16_bf16 v[192:195], v[152:153], v[188:189], v[192:195]
  s_nop 1
  v_mfma_f32_16x16x16_bf16 v[196:199], v[152:153], v[190:191], v[196:199]
  v_rcp_f32 v200, v200
  v_mfma_f32_16x16x32_bf16 v[216:219], v[120:123], v[184:187], 0
  v_mfma_f32_16x16x32_bf16 v[220:223], v[124:127], v[184:187], 0
  s_nop 1
  v_mfma_f32_16x16x16_bf16 v[216:219], v[154:155], v[188:189], v[216:219]
  s_nop 1
  v_mfma_f32_16x16x16_bf16 v[220:223], v[154:155], v[190:191], v[220:223]
  v_pk_mul_f32 v[192:193], v[192:193], v[200:201] op_sel_hi:[1,0]
  v_pk_mul_f32 v[194:195], v[194:195], v[200:201] op_sel_hi:[1,0]
  v_pk_mul_f32 v[196:197], v[196:197], v[200:201] op_sel_hi:[1,0]
  v_pk_mul_f32 v[198:199], v[198:199], v[200:201] op_sel_hi:[1,0]
  v_cvt_pk_bf16_f32 v224, v192, v196
  v_cvt_pk_bf16_f32 v225, v193, v197
  v_cvt_pk_bf16_f32 v226, v194, v198
  v_cvt_pk_bf16_f32 v227, v195, v199
  global_store_dwordx4 v7, v[224:227], s[40:41] offset:0 sc1
  v_mfma_f32_16x16x32_bf16 v[192:195], v[128:131], v[184:187], 0
  v_mfma_f32_16x16x32_bf16 v[196:199], v[132:135], v[184:187], 0
  s_nop 1
  v_mfma_f32_16x16x16_bf16 v[192:195], v[156:157], v[188:189], v[192:195]
  s_nop 1
  v_mfma_f32_16x16x16_bf16 v[196:199], v[156:157], v[190:191], v[196:199]
  v_pk_mul_f32 v[216:217], v[216:217], v[200:201] op_sel_hi:[1,0]
  v_pk_mul_f32 v[218:219], v[218:219], v[200:201] op_sel_hi:[1,0]
  v_pk_mul_f32 v[220:221], v[220:221], v[200:201] op_sel_hi:[1,0]
  v_pk_mul_f32 v[222:223], v[222:223], v[200:201] op_sel_hi:[1,0]
  v_cvt_pk_bf16_f32 v228, v216, v220
  v_cvt_pk_bf16_f32 v229, v217, v221
  v_cvt_pk_bf16_f32 v230, v218, v222
  v_cvt_pk_bf16_f32 v231, v219, v223
  global_store_dwordx4 v7, v[228:231], s[40:41] offset:2048 sc1
  v_mfma_f32_16x16x32_bf16 v[216:219], v[136:139], v[184:187], 0
  v_mfma_f32_16x16x32_bf16 v[220:223], v[140:143], v[184:187], 0
  s_nop 1
  v_mfma_f32_16x16x16_bf16 v[216:219], v[158:159], v[188:189], v[216:219]
  s_nop 1
  v_mfma_f32_16x16x16_bf16 v[220:223], v[158:159], v[190:191], v[220:223]
  v_pk_mul_f32 v[192:193], v[192:193], v[200:201] op_sel_hi:[1,0]
  v_pk_mul_f32 v[194:195], v[194:195], v[200:201] op_sel_hi:[1,0]
  v_pk_mul_f32 v[196:197], v[196:197], v[200:201] op_sel_hi:[1,0]
  v_pk_mul_f32 v[198:199], v[198:199], v[200:201] op_sel_hi:[1,0]
  v_cvt_pk_bf16_f32 v224, v192, v196
  v_cvt_pk_bf16_f32 v225, v193, v197
  v_cvt_pk_bf16_f32 v226, v194, v198
  v_cvt_pk_bf16_f32 v227, v195, v199
  global_store_dwordx4 v8, v[224:227], s[40:41] offset:0 sc1
  v_pk_mul_f32 v[216:217], v[216:217], v[200:201] op_sel_hi:[1,0]
  v_pk_mul_f32 v[218:219], v[218:219], v[200:201] op_sel_hi:[1,0]
  v_pk_mul_f32 v[220:221], v[220:221], v[200:201] op_sel_hi:[1,0]
  v_pk_mul_f32 v[222:223], v[222:223], v[200:201] op_sel_hi:[1,0]
  v_cvt_pk_bf16_f32 v228, v216, v220
  v_cvt_pk_bf16_f32 v229, v217, v221
  v_cvt_pk_bf16_f32 v230, v218, v222
  v_cvt_pk_bf16_f32 v231, v219, v223
  global_store_dwordx4 v8, v[228:231], s[40:41] offset:2048 sc1
  v_max3_f32 v213, v180, v181, v182
  v_max3_f32 v212, v172, v173, v174
  v_max3_f32 v213, v213, v183, v175
  v_max3_f32 v212, v212, v176, v177
  v_max3_f32 v213, v213, v178, v179
  v_max_f32 v212, v212, v213
  v_mov_b32 v213, v212
  s_nop 1
  v_permlane32_swap_b32 v212, v213
  v_max_f32 v212, v212, v213
  v_mov_b32 v213, v212
  s_nop 1
  v_permlane16_swap_b32 v212, v213
  v_max_f32 v212, v212, v213
  v_mul_f32 v214, s32, v212
  v_pk_fma_f32 v[172:173], v[172:173], s[32:33], v[214:215] op_sel_hi:[1,1,0] neg_lo:[0,0,1] neg_hi:[0,0,1]
  v_pk_fma_f32 v[174:175], v[174:175], s[32:33], v[214:215] op_sel_hi:[1,1,0] neg_lo:[0,0,1] neg_hi:[0,0,1]
  v_pk_fma_f32 v[176:177], v[176:177], s[32:33], v[214:215] op_sel_hi:[1,1,0] neg_lo:[0,0,1] neg_hi:[0,0,1]
  v_pk_fma_f32 v[178:179], v[178:179], s[32:33], v[214:215] op_sel_hi:[1,1,0] neg_lo:[0,0,1] neg_hi:[0,0,1]
  v_pk_fma_f32 v[180:181], v[180:181], s[32:33], v[214:215] op_sel_hi:[1,1,0] neg_lo:[0,0,1] neg_hi:[0,0,1]
  v_pk_fma_f32 v[182:183], v[182:183], s[32:33], v[214:215] op_sel_hi:[1,1,0] neg_lo:[0,0,1] neg_hi:[0,0,1]
  v_exp_f32 v172, v172
  v_exp_f32 v173, v173
  v_exp_f32 v174, v174
  v_exp_f32 v175, v175
  v_exp_f32 v176, v176
  v_exp_f32 v177, v177
  v_exp_f32 v178, v178
  v_exp_f32 v179, v179
  v_exp_f32 v180, v180
  v_exp_f32 v181, v181
  v_exp_f32 v182, v182
  v_exp_f32 v183, v183
  v_cvt_pk_bf16_f32 v184, v172, v173
  v_cvt_pk_bf16_f32 v185, v174, v175
  v_cvt_pk_bf16_f32 v186, v176, v177
  v_cvt_pk_bf16_f32 v187, v178, v179
  v_cvt_pk_bf16_f32 v190, v180, v181
  v_cvt_pk_bf16_f32 v191, v182, v183
  v_cndmask_b32 v188, 0, v190, s[34:35]
  v_cndmask_b32 v189, 0, v191, s[34:35]
  v_cndmask_b32 v190, 0, v190, s[36:37]
  v_cndmask_b32 v191, 0, v191, s[36:37]
  v_mfma_f32_16x16x32_bf16 v[200:203], v[208:211], v[184:187], 0
  s_nop 5
  v_mfma_f32_16x16x16_bf16 v[200:203], v[208:209], v[188:189], v[200:203]
  v_mfma_f32_16x16x32_bf16 v[192:195], v[112:115], v[184:187], 0
  v_mfma_f32_16x16x32_bf16 v[196:199], v[116:119], v[184:187], 0
  s_nop 1
  v_mfma_f32_16x16x16_bf16 v[192:195], v[152:153], v[188:189], v[192:195]
  s_nop 1
  v_mfma_f32_16x16x16_bf16 v[196:199], v[152:153], v[190:191], v[196:199]
  v_rcp_f32 v200, v200
  v_mfma_f32_16x16x32_bf16 v[216:219], v[120:123], v[184:187], 0
  v_mfma_f32_16x16x32_bf16 v[220:223], v[124:127], v[184:187], 0
  s_nop 1
  v_mfma_f32_16x16x16_bf16 v[216:219], v[154:155], v[188:189], v[216:219]
  s_nop 1
  v_mfma_f32_16x16x16_bf16 v[220:223], v[154:155], v[190:191], v[220:223]
  v_pk_mul_f32 v[192:193], v[192:193], v[200:201] op_sel_hi:[1,0]
  v_pk_mul_f32 v[194:195], v[194:195], v[200:201] op_sel_hi:[1,0]
  v_pk_mul_f32 v[196:197], v[196:197], v[200:201] op_sel_hi:[1,0]
  v_pk_mul_f32 v[198:199], v[198:199], v[200:201] op_sel_hi:[1,0]
  v_cvt_pk_bf16_f32 v224, v192, v196
  v_cvt_pk_bf16_f32 v225, v193, v197
  v_cvt_pk_bf16_f32 v226, v194, v198
  v_cvt_pk_bf16_f32 v227, v195, v199
  global_store_dwordx4 v7, v[224:227], s[40:41] offset:256 sc1
  v_mfma_f32_16x16x32_bf16 v[192:195], v[128:131], v[184:187], 0
  v_mfma_f32_16x16x32_bf16 v[196:199], v[132:135], v[184:187], 0
  s_nop 1
  v_mfma_f32_16x16x16_bf16 v[192:195], v[156:157], v[188:189], v[192:195]
  s_nop 1
  v_mfma_f32_16x16x16_bf16 v[196:199], v[156:157], v[190:191], v[196:199]
  v_pk_mul_f32 v[216:217], v[216:217], v[200:201] op_sel_hi:[1,0]
  v_pk_mul_f32 v[218:219], v[218:219], v[200:201] op_sel_hi:[1,0]
  v_pk_mul_f32 v[220:221], v[220:221], v[200:201] op_sel_hi:[1,0]
  v_pk_mul_f32 v[222:223], v[222:223], v[200:201] op_sel_hi:[1,0]
  v_cvt_pk_bf16_f32 v228, v216, v220
  v_cvt_pk_bf16_f32 v229, v217, v221
  v_cvt_pk_bf16_f32 v230, v218, v222
  v_cvt_pk_bf16_f32 v231, v219, v223
  global_store_dwordx4 v7, v[228:231], s[40:41] offset:2304 sc1
  v_mfma_f32_16x16x32_bf16 v[216:219], v[136:139], v[184:187], 0
  v_mfma_f32_16x16x32_bf16 v[220:223], v[140:143], v[184:187], 0
  s_nop 1
  v_mfma_f32_16x16x16_bf16 v[216:219], v[158:159], v[188:189], v[216:219]
  s_nop 1
  v_mfma_f32_16x16x16_bf16 v[220:223], v[158:159], v[190:191], v[220:223]
  v_pk_mul_f32 v[192:193], v[192:193], v[200:201] op_sel_hi:[1,0]
  v_pk_mul_f32 v[194:195], v[194:195], v[200:201] op_sel_hi:[1,0]
  v_pk_mul_f32 v[196:197], v[196:197], v[200:201] op_sel_hi:[1,0]
  v_pk_mul_f32 v[198:199], v[198:199], v[200:201] op_sel_hi:[1,0]
  v_cvt_pk_bf16_f32 v224, v192, v196
  v_cvt_pk_bf16_f32 v225, v193, v197
  v_cvt_pk_bf16_f32 v226, v194, v198
  v_cvt_pk_bf16_f32 v227, v195, v199
  global_store_dwordx4 v8, v[224:227], s[40:41] offset:256 sc1
  v_pk_mul_f32 v[216:217], v[216:217], v[200:201] op_sel_hi:[1,0]
  v_pk_mul_f32 v[218:219], v[218:219], v[200:201] op_sel_hi:[1,0]
  v_pk_mul_f32 v[220:221], v[220:221], v[200:201] op_sel_hi:[1,0]
  v_pk_mul_f32 v[222:223], v[222:223], v[200:201] op_sel_hi:[1,0]
  v_cvt_pk_bf16_f32 v228, v216, v220
  v_cvt_pk_bf16_f32 v229, v217, v221
  v_cvt_pk_bf16_f32 v230, v218, v222
  v_cvt_pk_bf16_f32 v231, v219, v223
  global_store_dwordx4 v8, v[228:231], s[40:41] offset:2304 sc1
  s_waitcnt vmcnt(0)
  s_lshl_b32 s55, s53, 7
  s_add_u32 s55, s55, 606208
  v_mov_b32 v20, s55
  v_mov_b32 v21, 1
  s_mov_b64 exec, 1
  global_atomic_add v20, v21, s[8:9] sc1
  s_mov_b64 exec, -1
  s_add_u32 s53, s53, s52
  s_cmp_lt_u32 s53, 64
  s_cbranch_scc1 L_a_item
L_a_exit:
L_end:
  s_waitcnt vmcnt(0)
  s_endpgm
.section .rodata,"a"
.p2align 6
.amdhsa_kernel gated_mix__memory_aug_recurrent_mem_tr__dense_activation_relu__prompt_kernel
  .amdhsa_next_free_vgpr 512
  .amdhsa_next_free_sgpr 102
  .amdhsa_accum_offset 256
  .amdhsa_group_segment_fixed_size 0
  .amdhsa_kernarg_size 112
  .amdhsa_user_sgpr_count 2
  .amdhsa_user_sgpr_kernarg_segment_ptr 1
  .amdhsa_system_sgpr_workgroup_id_x 1
.end_amdhsa_kernel
```
